```python
import torch

def _softmax(x, axis=-1):
    return torch.softmax(x, dim=axis)
def _gelu(x):
    return torch.nn.functional.gelu(x, approximate="tanh")
def _silu(x):
    return torch.nn.functional.silu(x)
def _sigmoid(x):
    return torch.sigmoid(x)
def _layernorm(x, axis=-1, eps=1e-5):
    m = x.mean(dim=axis, keepdim=True)
    v = x.var(dim=axis, keepdim=True, unbiased=False)
    return (x - m) / torch.sqrt(v + eps)
def _scatter_add(tgt, idx, src, axis=0):
    return tgt.clone().index_add_(axis, idx, src)
def _segment_sum(src, seg, n):
    out = torch.zeros((n,) + src.shape[1:], dtype=src.dtype)
    return out.index_add_(0, seg, src)
def _pad(x, pw):
    flat = tuple(v for pair in reversed(pw) for v in pair)
    return torch.nn.functional.pad(x, flat)

kernel_name = 'standalone__paged_block_table_kv_pagedattention__sampling'

def setup_inputs():

    _w = (lambda a: (lambda t: t.to(torch.bfloat16) if t.is_floating_point() else t)(torch.as_tensor(a)))
    B, Hq, Hkv, Sq, Skv, D = 8, 32, 4, 32, 8192, 128
    bs = 16
    nbps = max(1, Skv // bs)
    num_phys = B * nbps + 4
    bt = torch.randperm(num_phys)[: B * nbps].reshape(B, nbps).to(torch.int64)
    cl = (nbps * bs - (torch.arange(1, B + 1, dtype=torch.int64) * 2654435761) % max(1, nbps * bs // 2)).to(torch.int64)
    return {
        "q": _w((lambda *s: torch.randn(*s, dtype=torch.bfloat16) * 0.8)(B, Hq, Sq, D)),
        "k_cache": _w((lambda *s: torch.randn(*s, dtype=torch.bfloat16) * 0.8)(num_phys, bs, Hkv, D)),
        "v_cache": _w((lambda *s: torch.randn(*s, dtype=torch.bfloat16) * 0.05)(num_phys, bs, Hkv, D)),
        "block_table": _w(bt),
        "context_lens": _w(cl),
    }

def reference(q, k_cache, v_cache, block_table, context_lens):
    B, Hq, Sq, D = q.shape
    bs = k_cache.shape[1]
    Hkv = k_cache.shape[2]
    nbps = block_table.shape[1]
    Skv = nbps * bs
    bt = block_table.reshape(-1)
    k = (lambda x, *d: x.permute(*d))(k_cache[bt].reshape(B, Skv, Hkv, D), 0, 2, 1, 3)
    v = (lambda x, *d: x.permute(*d))(v_cache[bt].reshape(B, Skv, Hkv, D), 0, 2, 1, 3)
    g = Hq // Hkv
    qg = q.reshape(B, Hkv, g, Sq, D)
    scores = torch.einsum("bhgqd,bhkd->bhgqk", qg, k) * (D ** -0.5)
    pos = torch.arange(Skv)
    msk = pos[None, :] < context_lens[:, None]
    scores = torch.where(msk[:, None, None, None, :], scores, -1e9)
    p = _softmax(scores, axis=-1)
    out = torch.einsum("bhgqk,bhkd->bhgqd", p, v)
    return out.reshape(B, Hq, Sq, D)
```

```asm
; @launch grid=(256,1,1) block=(256,1,1) lds=131328
.amdgcn_target "amdgcn-amd-amdhsa--gfx950"
.text
.globl standalone__paged_block_table_kv_pagedattention__sampling_kernel
.p2align 8
.type standalone__paged_block_table_kv_pagedattention__sampling_kernel,@function
standalone__paged_block_table_kv_pagedattention__sampling_kernel:
  s_cmp_ge_u32 s2, 0x100
  s_cbranch_scc1 L_exit1
  s_load_dwordx16 s[4:19], s[0:1], 0
  v_lshrrev_b32 v1, 6, v0
  v_and_b32 v161, 63, v0
  v_readfirstlane_b32 s20, v1
  s_and_b32 s82, s2, 7
  s_lshr_b32 s64, s82, 1
  s_and_b32 s82, s82, 1
  s_lshl_b32 s82, s82, 5
  s_lshr_b32 s65, s2, 3
  s_add_u32 s65, s65, s82
  v_lshrrev_b32 v194, 4, v161
  v_and_b32 v196, 15, v161
  v_xor_b32 v196, v196, v194
  v_lshlrev_b32 v194, 8, v194
  v_xor_b32 v197, 0, v196
  v_lshl_add_u32 v202, v197, 4, v194
  v_xor_b32 v197, 4, v196
  v_lshl_add_u32 v203, v197, 4, v194
  v_xor_b32 v197, 8, v196
  v_lshl_add_u32 v204, v197, 4, v194
  v_xor_b32 v197, 12, v196
  v_lshl_add_u32 v205, v197, 4, v194
  s_mov_b32 s3, 0
  s_mov_b32 s82, 0
  s_mov_b32 s83, 179
  s_cmp_ge_u32 s65, 7
  s_cselect_b32 s82, 7, s82
  s_cselect_b32 s83, 229, s83
  s_addc_u32 s3, s3, 0
  s_cmp_ge_u32 s65, 16
  s_cselect_b32 s82, 16, s82
  s_cselect_b32 s83, 152, s83
  s_addc_u32 s3, s3, 0
  s_cmp_ge_u32 s65, 22
  s_cselect_b32 s82, 22, s82
  s_cselect_b32 s83, 202, s83
  s_addc_u32 s3, s3, 0
  s_cmp_ge_u32 s65, 32
  s_cselect_b32 s82, 32, s82
  s_cselect_b32 s83, 253, s83
  s_addc_u32 s3, s3, 0
  s_cmp_ge_u32 s65, 42
  s_cselect_b32 s82, 42, s82
  s_cselect_b32 s83, 175, s83
  s_addc_u32 s3, s3, 0
  s_cmp_ge_u32 s65, 49
  s_cselect_b32 s82, 49, s82
  s_cselect_b32 s83, 226, s83
  s_addc_u32 s3, s3, 0
  s_cmp_ge_u32 s65, 58
  s_cselect_b32 s82, 58, s82
  s_cselect_b32 s83, 148, s83
  s_addc_u32 s3, s3, 0
  s_sub_u32 s82, s65, s82
  s_mul_i32 s21, s82, 26
  s_add_u32 s100, s21, 26
  s_min_u32 s100, s100, s83
  s_min_u32 s21, s21, s100
  s_lshl_b32 s79, s20, 12
  s_lshl_b32 s89, s20, 14
  s_and_b32 s95, s65, 1
  s_lshl_b32 s90, s95, 13
  s_lshl_b32 s88, s3, 18
  s_lshl_b32 s91, s64, 16
  s_add_u32 s88, s88, s91
  s_add_u32 s88, s88, s89
  s_sub_u32 s84, s100, 1
  s_sub_u32 s85, s21, 1
  v_add_u32 v194, s85, v161
  v_mov_b32 v195, s84
  v_cmp_eq_u32 vcc, 0, v161
  s_lshl_b32 s86, s3, 11
  s_and_b32 s87, s20, 1
  v_cndmask_b32 v194, v194, v195, vcc
  s_lshl_b32 s87, s87, 2
  s_add_u32 s86, s86, s87
  v_lshlrev_b32 v194, 3, v194
  v_add_u32 v194, s86, v194
  s_sub_u32 s87, s100, s21
  s_lshl_b32 s86, s64, 8
  s_waitcnt lgkmcnt(0)
  s_mov_b32 s48, s10
  s_mov_b32 s49, s11
  s_mov_b32 s50, 16384
  s_mov_b32 s51, 0x20000
  buffer_load_dword v144, v194, s[48:51], 0 offen
  s_load_dwordx8 s[24:31], s[12:13], 0
  s_mov_b32 s56, s4
  s_mov_b32 s57, s5
  s_mov_b32 s58, 2097152
  s_mov_b32 s59, 0x20000
  s_mov_b32 s91, s90
  s_add_u32 s92, s88, s91
  s_add_u32 m0, s79, 65536
  s_nop 0
  buffer_load_dwordx4 v202, s[56:59], s92 offen offset:0 lds
  buffer_load_dwordx4 v203, s[56:59], s92 offen offset:1024 lds
  buffer_load_dwordx4 v204, s[56:59], s92 offen offset:2048 lds
  buffer_load_dwordx4 v205, s[56:59], s92 offen offset:3072 lds
  s_add_u32 m0, s79, 81920
  s_add_u32 s92, s92, 4096
  buffer_load_dwordx4 v202, s[56:59], s92 offen offset:0 lds
  buffer_load_dwordx4 v203, s[56:59], s92 offen offset:1024 lds
  buffer_load_dwordx4 v204, s[56:59], s92 offen offset:2048 lds
  buffer_load_dwordx4 v205, s[56:59], s92 offen offset:3072 lds
  s_cmp_lt_u32 s20, 2
  s_cselect_b32 s52, s6, s8
  s_cselect_b32 s53, s7, s9
  s_mov_b32 s54, 67174400
  s_mov_b32 s55, 0x20000
  v_lshrrev_b32 v197, 4, v161
  v_and_b32 v198, 15, v161
  s_cselect_b32 s82, 2, 3
  s_cselect_b32 s83, 1, 2
  v_lshlrev_b32 v196, s82, v197
  v_and_b32 v196, 15, v196
  v_xor_b32 v198, v198, v196
  v_lshlrev_b32 v197, 12, v197
  s_mul_i32 s84, s83, 0
  v_xor_b32 v196, s84, v198
  v_lshl_add_u32 v140, v196, 4, v197
  s_mul_i32 s84, s83, 1
  v_xor_b32 v196, s84, v198
  v_lshl_add_u32 v141, v196, 4, v197
  s_mul_i32 s84, s83, 2
  v_xor_b32 v196, s84, v198
  v_lshl_add_u32 v142, v196, 4, v197
  s_mul_i32 s84, s83, 3
  v_xor_b32 v196, s84, v198
  v_lshl_add_u32 v143, v196, 4, v197
  v_mov_b32 v195, 0x80000000
  v_cmp_gt_u32 vcc, s87, v161
  s_waitcnt vmcnt(8)
  v_lshlrev_b32 v144, 14, v144
  v_add_u32 v144, s86, v144
  v_cndmask_b32 v144, v195, v144, vcc
  s_nop 0
  v_readlane_b32 s93, v144, 0
  v_readlane_b32 s94, v144, 1
  s_nop 2
  s_add_u32 m0, s79, 0
  s_nop 0
  buffer_load_dwordx4 v140, s[52:55], s93 offen offset:0 nt lds
  buffer_load_dwordx4 v141, s[52:55], s93 offen offset:1024 nt lds
  buffer_load_dwordx4 v142, s[52:55], s93 offen offset:2048 nt lds
  buffer_load_dwordx4 v143, s[52:55], s93 offen offset:3072 nt lds
  s_xor_b32 s91, s90, 0x2000
  s_add_u32 s92, s88, s91
  s_add_u32 m0, s79, 98304
  s_nop 0
  buffer_load_dwordx4 v202, s[56:59], s92 offen offset:0 lds
  buffer_load_dwordx4 v203, s[56:59], s92 offen offset:1024 lds
  buffer_load_dwordx4 v204, s[56:59], s92 offen offset:2048 lds
  buffer_load_dwordx4 v205, s[56:59], s92 offen offset:3072 lds
  s_add_u32 m0, s79, 114688
  s_add_u32 s92, s92, 4096
  buffer_load_dwordx4 v202, s[56:59], s92 offen offset:0 lds
  buffer_load_dwordx4 v203, s[56:59], s92 offen offset:1024 lds
  buffer_load_dwordx4 v204, s[56:59], s92 offen offset:2048 lds
  buffer_load_dwordx4 v205, s[56:59], s92 offen offset:3072 lds
  s_add_u32 m0, s79, 16384
  s_nop 0
  buffer_load_dwordx4 v140, s[52:55], s94 offen offset:0 nt lds
  buffer_load_dwordx4 v141, s[52:55], s94 offen offset:1024 nt lds
  buffer_load_dwordx4 v142, s[52:55], s94 offen offset:2048 nt lds
  buffer_load_dwordx4 v143, s[52:55], s94 offen offset:3072 nt lds
  s_waitcnt lgkmcnt(0)
  v_add_u32 v182, 1, v161
  v_cvt_f32_u32 v182, v182
  v_rcp_f32 v182, v182
  s_add_u32 s32, s24, 31
  s_lshr_b32 s32, s32, 5
  s_min_u32 s32, s32, 0x100
  s_cmp_lt_i32 s24, 1
  s_cselect_b32 s32, 0x100, s32
  s_add_u32 s33, s25, 31
  s_lshr_b32 s33, s33, 5
  s_min_u32 s33, s33, 0x100
  s_cmp_lt_i32 s25, 1
  s_cselect_b32 s33, 0x100, s33
  s_add_u32 s34, s26, 31
  s_lshr_b32 s34, s34, 5
  s_min_u32 s34, s34, 0x100
  s_cmp_lt_i32 s26, 1
  s_cselect_b32 s34, 0x100, s34
  s_add_u32 s35, s27, 31
  s_lshr_b32 s35, s35, 5
  s_min_u32 s35, s35, 0x100
  s_cmp_lt_i32 s27, 1
  s_cselect_b32 s35, 0x100, s35
  s_add_u32 s36, s28, 31
  s_lshr_b32 s36, s36, 5
  s_min_u32 s36, s36, 0x100
  s_cmp_lt_i32 s28, 1
  s_cselect_b32 s36, 0x100, s36
  s_add_u32 s37, s29, 31
  s_lshr_b32 s37, s37, 5
  s_min_u32 s37, s37, 0x100
  s_cmp_lt_i32 s29, 1
  s_cselect_b32 s37, 0x100, s37
  s_add_u32 s38, s30, 31
  s_lshr_b32 s38, s38, 5
  s_min_u32 s38, s38, 0x100
  s_cmp_lt_i32 s30, 1
  s_cselect_b32 s38, 0x100, s38
  s_add_u32 s39, s31, 31
  s_lshr_b32 s39, s39, 5
  s_min_u32 s39, s39, 0x100
  s_cmp_lt_i32 s31, 1
  s_cselect_b32 s39, 0x100, s39
  v_mul_f32 v182, 0x47800000, v182
  v_cvt_u32_f32 v182, v182
  v_add_u32 v182, 2, v182
  v_add_u32 v183, s32, v161
  v_add_u32 v184, s33, v161
  v_add_u32 v185, s34, v161
  v_add_u32 v186, s35, v161
  v_add_u32 v187, s36, v161
  v_add_u32 v188, s37, v161
  v_add_u32 v189, s38, v161
  v_add_u32 v190, s39, v161
  v_mul_u32_u24 v183, v183, v182
  v_mul_u32_u24 v184, v184, v182
  v_mul_u32_u24 v185, v185, v182
  v_mul_u32_u24 v186, v186, v182
  v_mul_u32_u24 v187, v187, v182
  v_mul_u32_u24 v188, v188, v182
  v_mul_u32_u24 v189, v189, v182
  v_mul_u32_u24 v190, v190, v182
  v_lshrrev_b32 v183, 16, v183
  v_lshrrev_b32 v184, 16, v184
  v_lshrrev_b32 v185, 16, v185
  v_lshrrev_b32 v186, 16, v186
  v_lshrrev_b32 v187, 16, v187
  v_lshrrev_b32 v188, 16, v188
  v_lshrrev_b32 v189, 16, v189
  v_lshrrev_b32 v190, 16, v190
  v_add3_u32 v191, v183, v184, v185
  v_add3_u32 v192, v186, v187, v188
  v_add3_u32 v191, v191, v189, v190
  v_add_u32 v191, v191, v192
  v_cmp_ge_u32 vcc, 64, v191
  s_nop 1
  s_ff1_i32_b64 s68, vcc
  s_nop 1
  v_readlane_b32 s40, v183, s68
  v_readlane_b32 s41, v184, s68
  v_readlane_b32 s42, v185, s68
  v_readlane_b32 s43, v186, s68
  v_readlane_b32 s44, v187, s68
  v_readlane_b32 s45, v188, s68
  v_readlane_b32 s46, v189, s68
  v_readlane_b32 s47, v190, s68
  v_readlane_b32 s82, v191, s68
  s_add_u32 s68, s68, 1
  s_nop 1
  s_sub_u32 s82, 64, s82
  s_mov_b32 s83, 0
  s_mov_b32 s66, -1
  s_cmp_ge_u32 s65, s83
  s_cselect_b32 s101, s83, s101
  s_cselect_b32 s69, s32, s69
  s_cselect_b32 s70, s24, s70
  s_cselect_b32 s81, s40, s81
  s_addc_u32 s66, s66, 0
  s_add_u32 s83, s83, s40
  s_sub_u32 s84, 31, s83
  s_sub_u32 s85, s41, 1
  s_min_u32 s85, s85, s82
  s_cmp_lt_u32 s84, s85
  s_cselect_b32 s83, 32, s83
  s_cmp_ge_u32 s65, s83
  s_cselect_b32 s101, s83, s101
  s_cselect_b32 s69, s33, s69
  s_cselect_b32 s70, s25, s70
  s_cselect_b32 s81, s41, s81
  s_addc_u32 s66, s66, 0
  s_add_u32 s83, s83, s41
  s_sub_u32 s84, 31, s83
  s_sub_u32 s85, s42, 1
  s_min_u32 s85, s85, s82
  s_cmp_lt_u32 s84, s85
  s_cselect_b32 s83, 32, s83
  s_cmp_ge_u32 s65, s83
  s_cselect_b32 s101, s83, s101
  s_cselect_b32 s69, s34, s69
  s_cselect_b32 s70, s26, s70
  s_cselect_b32 s81, s42, s81
  s_addc_u32 s66, s66, 0
  s_add_u32 s83, s83, s42
  s_sub_u32 s84, 31, s83
  s_sub_u32 s85, s43, 1
  s_min_u32 s85, s85, s82
  s_cmp_lt_u32 s84, s85
  s_cselect_b32 s83, 32, s83
  s_cmp_ge_u32 s65, s83
  s_cselect_b32 s101, s83, s101
  s_cselect_b32 s69, s35, s69
  s_cselect_b32 s70, s27, s70
  s_cselect_b32 s81, s43, s81
  s_addc_u32 s66, s66, 0
  s_add_u32 s83, s83, s43
  s_sub_u32 s84, 31, s83
  s_sub_u32 s85, s44, 1
  s_min_u32 s85, s85, s82
  s_cmp_lt_u32 s84, s85
  s_cselect_b32 s83, 32, s83
  s_cmp_ge_u32 s65, s83
  s_cselect_b32 s101, s83, s101
  s_cselect_b32 s69, s36, s69
  s_cselect_b32 s70, s28, s70
  s_cselect_b32 s81, s44, s81
  s_addc_u32 s66, s66, 0
  s_add_u32 s83, s83, s44
  s_sub_u32 s84, 31, s83
  s_sub_u32 s85, s45, 1
  s_min_u32 s85, s85, s82
  s_cmp_lt_u32 s84, s85
  s_cselect_b32 s83, 32, s83
  s_cmp_ge_u32 s65, s83
  s_cselect_b32 s101, s83, s101
  s_cselect_b32 s69, s37, s69
  s_cselect_b32 s70, s29, s70
  s_cselect_b32 s81, s45, s81
  s_addc_u32 s66, s66, 0
  s_add_u32 s83, s83, s45
  s_sub_u32 s84, 31, s83
  s_sub_u32 s85, s46, 1
  s_min_u32 s85, s85, s82
  s_cmp_lt_u32 s84, s85
  s_cselect_b32 s83, 32, s83
  s_cmp_ge_u32 s65, s83
  s_cselect_b32 s101, s83, s101
  s_cselect_b32 s69, s38, s69
  s_cselect_b32 s70, s30, s70
  s_cselect_b32 s81, s46, s81
  s_addc_u32 s66, s66, 0
  s_add_u32 s83, s83, s46
  s_sub_u32 s84, 31, s83
  s_sub_u32 s85, s47, 1
  s_min_u32 s85, s85, s82
  s_cmp_lt_u32 s84, s85
  s_cselect_b32 s83, 32, s83
  s_cmp_ge_u32 s65, s83
  s_cselect_b32 s101, s83, s101
  s_cselect_b32 s69, s39, s69
  s_cselect_b32 s70, s31, s70
  s_cselect_b32 s81, s47, s81
  s_addc_u32 s66, s66, 0
  s_add_u32 s83, s83, s47
  s_sub_u32 s67, s65, s101
  s_cmp_ge_u32 s67, s81
  s_cbranch_scc1 L_exit1w
  s_mul_i32 s71, s67, s68
  s_add_u32 s72, s71, s68
  s_min_u32 s72, s72, s69
  s_sub_u32 s73, s72, s71
  s_cmp_lg_u32 s66, s3
  s_cbranch_scc1 L_redo
  s_cmp_lg_u32 s71, s21
  s_cbranch_scc1 L_redo
  s_cmp_lg_u32 s72, s100
  s_cbranch_scc1 L_redo
L_redo_back:
  s_cmp_lt_i32 s70, 1
  s_cselect_b32 s75, 0, 0x3e0293ee
  s_cselect_b32 s70, 0x2000, s70
  s_min_u32 s70, s70, 0x2000
  s_sub_u32 s84, s72, 1
  s_lshl_b32 s84, s84, 5
  s_sub_u32 s74, s70, s84
  s_min_u32 s74, s74, 32
  s_mov_b32 s76, 4
  s_add_u32 s77, s73, 4
  s_mov_b32 s80, 0x40004000
  s_mov_b32 s60, s18
  s_mov_b32 s61, s19
  s_mov_b32 s62, 17334272
  s_mov_b32 s63, 0x20000
  v_mov_b32 v206, 0
  s_mov_b32 s48, s16
  s_mov_b32 s49, s17
  s_mov_b32 s50, 256
  s_lshl_b32 s21, s66, 2
  s_add_u32 s21, s21, s64
  s_lshl_b32 s21, s21, 2
  s_lshl_b32 s100, s64, 6
  s_add_u32 s100, s100, s65
  s_lshl_b32 s100, s100, 7
  s_add_u32 s100, s100, 17301504
  v_and_b32 v194, 15, v161
  v_lshrrev_b32 v195, 4, v161
  v_xor_b32 v197, v194, v195
  v_and_b32 v196, 3, v194
  v_lshlrev_b32 v196, 10, v196
  v_lshrrev_b32 v198, 2, v194
  v_lshl_add_u32 v196, v198, 8, v196
  v_lshl_add_u32 v128, v197, 4, v196
  v_xor_b32 v129, 64, v128
  v_xor_b32 v130, 128, v128
  v_xor_b32 v131, 192, v128
  v_lshlrev_b32 v199, 8, v194
  v_lshl_add_u32 v199, v197, 4, v199
  s_add_u32 s82, s79, 65536
  v_add_u32 v148, s82, v199
  v_xor_b32 v149, 64, v148
  v_xor_b32 v150, 128, v148
  v_xor_b32 v151, 192, v148
  v_lshlrev_b32 v196, 10, v198
  v_lshl_add_u32 v196, v195, 8, v196
  v_and_b32 v197, 1, v195
  v_lshl_add_u32 v197, v197, 2, v198
  v_lshl_add_u32 v196, v197, 5, v196
  v_and_b32 v197, 3, v194
  v_lshl_add_u32 v132, v197, 3, v196
  v_xor_b32 v133, 32, v132
  v_xor_b32 v134, 64, v132
  v_xor_b32 v135, 96, v132
  v_xor_b32 v136, 128, v132
  v_xor_b32 v137, 160, v132
  v_xor_b32 v138, 192, v132
  v_xor_b32 v139, 224, v132
  v_lshlrev_b32 v195, 2, v195
  v_sub_u32 v195, s74, v195
  v_mov_b32 v196, 0xff800000
  v_cmp_ge_i32 s[84:85], 0, v195
  v_cmp_ge_i32 s[86:87], 1, v195
  v_cmp_ge_i32 s[88:89], 2, v195
  v_cmp_ge_i32 s[90:91], 3, v195
  v_cndmask_b32 v208, 0, v196, s[84:85]
  v_cndmask_b32 v209, 0, v196, s[86:87]
  v_cndmask_b32 v210, 0, v196, s[88:89]
  v_cndmask_b32 v211, 0, v196, s[90:91]
  v_cmp_ge_i32 s[84:85], 16, v195
  v_cmp_ge_i32 s[86:87], 17, v195
  v_cmp_ge_i32 s[88:89], 18, v195
  v_cmp_ge_i32 s[90:91], 19, v195
  v_cndmask_b32 v212, 0, v196, s[84:85]
  v_cndmask_b32 v213, 0, v196, s[86:87]
  v_cndmask_b32 v214, 0, v196, s[88:89]
  v_cndmask_b32 v215, 0, v196, s[90:91]
  v_accvgpr_write_b32 a0, 0
  v_accvgpr_write_b32 a1, 0
  v_accvgpr_write_b32 a2, 0
  v_accvgpr_write_b32 a3, 0
  v_accvgpr_write_b32 a4, 0
  v_accvgpr_write_b32 a5, 0
  v_accvgpr_write_b32 a6, 0
  v_accvgpr_write_b32 a7, 0
  v_accvgpr_write_b32 a8, 0
  v_accvgpr_write_b32 a9, 0
  v_accvgpr_write_b32 a10, 0
  v_accvgpr_write_b32 a11, 0
  v_accvgpr_write_b32 a12, 0
  v_accvgpr_write_b32 a13, 0
  v_accvgpr_write_b32 a14, 0
  v_accvgpr_write_b32 a15, 0
  v_accvgpr_write_b32 a16, 0
  v_accvgpr_write_b32 a17, 0
  v_accvgpr_write_b32 a18, 0
  v_accvgpr_write_b32 a19, 0
  v_accvgpr_write_b32 a20, 0
  v_accvgpr_write_b32 a21, 0
  v_accvgpr_write_b32 a22, 0
  v_accvgpr_write_b32 a23, 0
  v_accvgpr_write_b32 a24, 0
  v_accvgpr_write_b32 a25, 0
  v_accvgpr_write_b32 a26, 0
  v_accvgpr_write_b32 a27, 0
  v_accvgpr_write_b32 a28, 0
  v_accvgpr_write_b32 a29, 0
  v_accvgpr_write_b32 a30, 0
  v_accvgpr_write_b32 a31, 0
  v_accvgpr_write_b32 a32, 0
  v_accvgpr_write_b32 a33, 0
  v_accvgpr_write_b32 a34, 0
  v_accvgpr_write_b32 a35, 0
  v_accvgpr_write_b32 a36, 0
  v_accvgpr_write_b32 a37, 0
  v_accvgpr_write_b32 a38, 0
  v_accvgpr_write_b32 a39, 0
  v_accvgpr_write_b32 a40, 0
  v_accvgpr_write_b32 a41, 0
  v_accvgpr_write_b32 a42, 0
  v_accvgpr_write_b32 a43, 0
  v_accvgpr_write_b32 a44, 0
  v_accvgpr_write_b32 a45, 0
  v_accvgpr_write_b32 a46, 0
  v_accvgpr_write_b32 a47, 0
  v_accvgpr_write_b32 a48, 0
  v_accvgpr_write_b32 a49, 0
  v_accvgpr_write_b32 a50, 0
  v_accvgpr_write_b32 a51, 0
  v_accvgpr_write_b32 a52, 0
  v_accvgpr_write_b32 a53, 0
  v_accvgpr_write_b32 a54, 0
  v_accvgpr_write_b32 a55, 0
  v_accvgpr_write_b32 a56, 0
  v_accvgpr_write_b32 a57, 0
  v_accvgpr_write_b32 a58, 0
  v_accvgpr_write_b32 a59, 0
  v_accvgpr_write_b32 a60, 0
  v_accvgpr_write_b32 a61, 0
  v_accvgpr_write_b32 a62, 0
  v_accvgpr_write_b32 a63, 0
  v_accvgpr_write_b32 a64, 0
  v_accvgpr_write_b32 a65, 0
  v_accvgpr_write_b32 a66, 0
  v_accvgpr_write_b32 a67, 0
  v_accvgpr_write_b32 a68, 0
  v_accvgpr_write_b32 a69, 0
  v_accvgpr_write_b32 a70, 0
  v_accvgpr_write_b32 a71, 0
  v_accvgpr_write_b32 a72, 0
  v_accvgpr_write_b32 a73, 0
  v_accvgpr_write_b32 a74, 0
  v_accvgpr_write_b32 a75, 0
  v_accvgpr_write_b32 a76, 0
  v_accvgpr_write_b32 a77, 0
  v_accvgpr_write_b32 a78, 0
  v_accvgpr_write_b32 a79, 0
  v_accvgpr_write_b32 a80, 0
  v_accvgpr_write_b32 a81, 0
  v_accvgpr_write_b32 a82, 0
  v_accvgpr_write_b32 a83, 0
  v_accvgpr_write_b32 a84, 0
  v_accvgpr_write_b32 a85, 0
  v_accvgpr_write_b32 a86, 0
  v_accvgpr_write_b32 a87, 0
  v_accvgpr_write_b32 a88, 0
  v_accvgpr_write_b32 a89, 0
  v_accvgpr_write_b32 a90, 0
  v_accvgpr_write_b32 a91, 0
  v_accvgpr_write_b32 a92, 0
  v_accvgpr_write_b32 a93, 0
  v_accvgpr_write_b32 a94, 0
  v_accvgpr_write_b32 a95, 0
  v_accvgpr_write_b32 a96, 0
  v_accvgpr_write_b32 a97, 0
  v_accvgpr_write_b32 a98, 0
  v_accvgpr_write_b32 a99, 0
  v_accvgpr_write_b32 a100, 0
  v_accvgpr_write_b32 a101, 0
  v_accvgpr_write_b32 a102, 0
  v_accvgpr_write_b32 a103, 0
  v_accvgpr_write_b32 a104, 0
  v_accvgpr_write_b32 a105, 0
  v_accvgpr_write_b32 a106, 0
  v_accvgpr_write_b32 a107, 0
  v_accvgpr_write_b32 a108, 0
  v_accvgpr_write_b32 a109, 0
  v_accvgpr_write_b32 a110, 0
  v_accvgpr_write_b32 a111, 0
  v_accvgpr_write_b32 a112, 0
  v_accvgpr_write_b32 a113, 0
  v_accvgpr_write_b32 a114, 0
  v_accvgpr_write_b32 a115, 0
  v_accvgpr_write_b32 a116, 0
  v_accvgpr_write_b32 a117, 0
  v_accvgpr_write_b32 a118, 0
  v_accvgpr_write_b32 a119, 0
  v_accvgpr_write_b32 a120, 0
  v_accvgpr_write_b32 a121, 0
  v_accvgpr_write_b32 a122, 0
  v_accvgpr_write_b32 a123, 0
  v_accvgpr_write_b32 a124, 0
  v_accvgpr_write_b32 a125, 0
  v_accvgpr_write_b32 a126, 0
  v_accvgpr_write_b32 a127, 0
  v_mov_b32 v224, 0
  v_mov_b32 v225, 0
  v_mov_b32 v226, 0
  v_mov_b32 v227, 0
  v_mov_b32 v228, 0
  v_mov_b32 v229, 0
  v_mov_b32 v230, 0
  v_mov_b32 v231, 0
  v_mov_b32 v232, 0
  v_mov_b32 v233, 0
  v_mov_b32 v234, 0
  v_mov_b32 v235, 0
  v_mov_b32 v236, 0
  v_mov_b32 v237, 0
  v_mov_b32 v238, 0
  v_mov_b32 v239, 0
  v_mov_b32 v196, 0x3f803f80
  v_accvgpr_write_b32 a192, v196
  v_accvgpr_write_b32 a193, v196
  v_accvgpr_write_b32 a194, v196
  v_accvgpr_write_b32 a195, v196
  s_mov_b32 s82, s75
  s_mov_b32 s83, s75
  s_waitcnt vmcnt(16)
  ds_read_b128 v[0:3], v148 offset:0
  ds_read_b128 v[4:7], v149 offset:0
  ds_read_b128 v[8:11], v150 offset:0
  ds_read_b128 v[12:15], v151 offset:0
  ds_read_b128 v[16:19], v148 offset:16384
  ds_read_b128 v[20:23], v149 offset:16384
  ds_read_b128 v[24:27], v150 offset:16384
  ds_read_b128 v[28:31], v151 offset:16384
  s_waitcnt lgkmcnt(0)
  v_lshlrev_b32 v162, 16, v0
  v_and_b32 v163, 0xffff0000, v0
  v_pk_mul_f32 v[162:163], v[162:163], s[82:83]
  v_cvt_pk_bf16_f32 v0, v162, v163
  v_lshlrev_b32 v164, 16, v1
  v_and_b32 v165, 0xffff0000, v1
  v_pk_mul_f32 v[164:165], v[164:165], s[82:83]
  v_cvt_pk_bf16_f32 v1, v164, v165
  v_lshlrev_b32 v166, 16, v2
  v_and_b32 v167, 0xffff0000, v2
  v_pk_mul_f32 v[166:167], v[166:167], s[82:83]
  v_cvt_pk_bf16_f32 v2, v166, v167
  v_lshlrev_b32 v168, 16, v3
  v_and_b32 v169, 0xffff0000, v3
  v_pk_mul_f32 v[168:169], v[168:169], s[82:83]
  v_cvt_pk_bf16_f32 v3, v168, v169
  v_lshlrev_b32 v162, 16, v4
  v_and_b32 v163, 0xffff0000, v4
  v_pk_mul_f32 v[162:163], v[162:163], s[82:83]
  v_cvt_pk_bf16_f32 v4, v162, v163
  v_lshlrev_b32 v164, 16, v5
  v_and_b32 v165, 0xffff0000, v5
  v_pk_mul_f32 v[164:165], v[164:165], s[82:83]
  v_cvt_pk_bf16_f32 v5, v164, v165
  v_lshlrev_b32 v166, 16, v6
  v_and_b32 v167, 0xffff0000, v6
  v_pk_mul_f32 v[166:167], v[166:167], s[82:83]
  v_cvt_pk_bf16_f32 v6, v166, v167
  v_lshlrev_b32 v168, 16, v7
  v_and_b32 v169, 0xffff0000, v7
  v_pk_mul_f32 v[168:169], v[168:169], s[82:83]
  v_cvt_pk_bf16_f32 v7, v168, v169
  v_lshlrev_b32 v162, 16, v8
  v_and_b32 v163, 0xffff0000, v8
  v_pk_mul_f32 v[162:163], v[162:163], s[82:83]
  v_cvt_pk_bf16_f32 v8, v162, v163
  v_lshlrev_b32 v164, 16, v9
  v_and_b32 v165, 0xffff0000, v9
  v_pk_mul_f32 v[164:165], v[164:165], s[82:83]
  v_cvt_pk_bf16_f32 v9, v164, v165
  v_lshlrev_b32 v166, 16, v10
  v_and_b32 v167, 0xffff0000, v10
  v_pk_mul_f32 v[166:167], v[166:167], s[82:83]
  v_cvt_pk_bf16_f32 v10, v166, v167
  v_lshlrev_b32 v168, 16, v11
  v_and_b32 v169, 0xffff0000, v11
  v_pk_mul_f32 v[168:169], v[168:169], s[82:83]
  v_cvt_pk_bf16_f32 v11, v168, v169
  v_lshlrev_b32 v162, 16, v12
  v_and_b32 v163, 0xffff0000, v12
  v_pk_mul_f32 v[162:163], v[162:163], s[82:83]
  v_cvt_pk_bf16_f32 v12, v162, v163
  v_lshlrev_b32 v164, 16, v13
  v_and_b32 v165, 0xffff0000, v13
  v_pk_mul_f32 v[164:165], v[164:165], s[82:83]
  v_cvt_pk_bf16_f32 v13, v164, v165
  v_lshlrev_b32 v166, 16, v14
  v_and_b32 v167, 0xffff0000, v14
  v_pk_mul_f32 v[166:167], v[166:167], s[82:83]
  v_cvt_pk_bf16_f32 v14, v166, v167
  v_lshlrev_b32 v168, 16, v15
  v_and_b32 v169, 0xffff0000, v15
  v_pk_mul_f32 v[168:169], v[168:169], s[82:83]
  v_cvt_pk_bf16_f32 v15, v168, v169
  v_lshlrev_b32 v162, 16, v16
  v_and_b32 v163, 0xffff0000, v16
  v_pk_mul_f32 v[162:163], v[162:163], s[82:83]
  v_cvt_pk_bf16_f32 v16, v162, v163
  v_lshlrev_b32 v164, 16, v17
  v_and_b32 v165, 0xffff0000, v17
  v_pk_mul_f32 v[164:165], v[164:165], s[82:83]
  v_cvt_pk_bf16_f32 v17, v164, v165
  v_lshlrev_b32 v166, 16, v18
  v_and_b32 v167, 0xffff0000, v18
  v_pk_mul_f32 v[166:167], v[166:167], s[82:83]
  v_cvt_pk_bf16_f32 v18, v166, v167
  v_lshlrev_b32 v168, 16, v19
  v_and_b32 v169, 0xffff0000, v19
  v_pk_mul_f32 v[168:169], v[168:169], s[82:83]
  v_cvt_pk_bf16_f32 v19, v168, v169
  v_lshlrev_b32 v162, 16, v20
  v_and_b32 v163, 0xffff0000, v20
  v_pk_mul_f32 v[162:163], v[162:163], s[82:83]
  v_cvt_pk_bf16_f32 v20, v162, v163
  v_lshlrev_b32 v164, 16, v21
  v_and_b32 v165, 0xffff0000, v21
  v_pk_mul_f32 v[164:165], v[164:165], s[82:83]
  v_cvt_pk_bf16_f32 v21, v164, v165
  v_lshlrev_b32 v166, 16, v22
  v_and_b32 v167, 0xffff0000, v22
  v_pk_mul_f32 v[166:167], v[166:167], s[82:83]
  v_cvt_pk_bf16_f32 v22, v166, v167
  v_lshlrev_b32 v168, 16, v23
  v_and_b32 v169, 0xffff0000, v23
  v_pk_mul_f32 v[168:169], v[168:169], s[82:83]
  v_cvt_pk_bf16_f32 v23, v168, v169
  v_lshlrev_b32 v162, 16, v24
  v_and_b32 v163, 0xffff0000, v24
  v_pk_mul_f32 v[162:163], v[162:163], s[82:83]
  v_cvt_pk_bf16_f32 v24, v162, v163
  v_lshlrev_b32 v164, 16, v25
  v_and_b32 v165, 0xffff0000, v25
  v_pk_mul_f32 v[164:165], v[164:165], s[82:83]
  v_cvt_pk_bf16_f32 v25, v164, v165
  v_lshlrev_b32 v166, 16, v26
  v_and_b32 v167, 0xffff0000, v26
  v_pk_mul_f32 v[166:167], v[166:167], s[82:83]
  v_cvt_pk_bf16_f32 v26, v166, v167
  v_lshlrev_b32 v168, 16, v27
  v_and_b32 v169, 0xffff0000, v27
  v_pk_mul_f32 v[168:169], v[168:169], s[82:83]
  v_cvt_pk_bf16_f32 v27, v168, v169
  v_lshlrev_b32 v162, 16, v28
  v_and_b32 v163, 0xffff0000, v28
  v_pk_mul_f32 v[162:163], v[162:163], s[82:83]
  v_cvt_pk_bf16_f32 v28, v162, v163
  v_lshlrev_b32 v164, 16, v29
  v_and_b32 v165, 0xffff0000, v29
  v_pk_mul_f32 v[164:165], v[164:165], s[82:83]
  v_cvt_pk_bf16_f32 v29, v164, v165
  v_lshlrev_b32 v166, 16, v30
  v_and_b32 v167, 0xffff0000, v30
  v_pk_mul_f32 v[166:167], v[166:167], s[82:83]
  v_cvt_pk_bf16_f32 v30, v166, v167
  v_lshlrev_b32 v168, 16, v31
  v_and_b32 v169, 0xffff0000, v31
  v_pk_mul_f32 v[168:169], v[168:169], s[82:83]
  v_cvt_pk_bf16_f32 v31, v168, v169
  s_waitcnt vmcnt(4)
  ds_read_b128 v[32:35], v148 offset:32768
  ds_read_b128 v[36:39], v149 offset:32768
  ds_read_b128 v[40:43], v150 offset:32768
  ds_read_b128 v[44:47], v151 offset:32768
  ds_read_b128 v[48:51], v148 offset:49152
  ds_read_b128 v[52:55], v149 offset:49152
  ds_read_b128 v[56:59], v150 offset:49152
  ds_read_b128 v[60:63], v151 offset:49152
  v_readlane_b32 s78, v144, 2
  s_nop 2
  s_add_u32 m0, s79, 32768
  s_nop 0
  buffer_load_dwordx4 v140, s[52:55], s78 offen offset:0 nt lds
  buffer_load_dwordx4 v141, s[52:55], s78 offen offset:1024 nt lds
  buffer_load_dwordx4 v142, s[52:55], s78 offen offset:2048 nt lds
  buffer_load_dwordx4 v143, s[52:55], s78 offen offset:3072 nt lds
  s_barrier
  ds_read_b128 a[128:131], v128 offset:0
  ds_read_b128 a[132:135], v129 offset:0
  ds_read_b128 a[136:139], v130 offset:0
  ds_read_b128 a[140:143], v131 offset:0
  ds_read_b128 a[144:147], v128 offset:4096
  ds_read_b128 a[148:151], v129 offset:4096
  ds_read_b128 a[152:155], v130 offset:4096
  ds_read_b128 a[156:159], v131 offset:4096
  ds_read_b64_tr_b16 a[160:161], v132 offset:8192
  ds_read_b64_tr_b16 a[162:163], v132 offset:12288
  ds_read_b64_tr_b16 a[164:165], v133 offset:8192
  ds_read_b64_tr_b16 a[166:167], v133 offset:12288
  ds_read_b64_tr_b16 a[168:169], v134 offset:8192
  ds_read_b64_tr_b16 a[170:171], v134 offset:12288
  ds_read_b64_tr_b16 a[172:173], v135 offset:8192
  ds_read_b64_tr_b16 a[174:175], v135 offset:12288
  ds_read_b64_tr_b16 a[176:177], v136 offset:8192
  ds_read_b64_tr_b16 a[178:179], v136 offset:12288
  ds_read_b64_tr_b16 a[180:181], v137 offset:8192
  ds_read_b64_tr_b16 a[182:183], v137 offset:12288
  ds_read_b64_tr_b16 a[184:185], v138 offset:8192
  ds_read_b64_tr_b16 a[186:187], v138 offset:12288
  ds_read_b64_tr_b16 a[188:189], v139 offset:8192
  ds_read_b64_tr_b16 a[190:191], v139 offset:12288
  s_waitcnt lgkmcnt(15)
  v_mfma_f32_16x16x32_bf16 v[64:67], a[128:131], v[0:3], v[208:211]
  v_lshlrev_b32 v152, 16, v32
  v_and_b32 v153, 0xffff0000, v32
  v_mul_f32 v152, s82, v152
  v_mul_f32 v153, s82, v153
  v_cvt_pk_bf16_f32 v32, v152, v153
  v_lshlrev_b32 v154, 16, v33
  v_and_b32 v155, 0xffff0000, v33
  v_mul_f32 v154, s82, v154
  v_mul_f32 v155, s82, v155
  v_cvt_pk_bf16_f32 v33, v154, v155
  v_mfma_f32_16x16x32_bf16 v[64:67], a[132:135], v[4:7], v[64:67]
  v_lshlrev_b32 v156, 16, v34
  v_and_b32 v157, 0xffff0000, v34
  v_mul_f32 v156, s82, v156
  v_mul_f32 v157, s82, v157
  v_cvt_pk_bf16_f32 v34, v156, v157
  v_lshlrev_b32 v158, 16, v35
  v_and_b32 v159, 0xffff0000, v35
  v_mul_f32 v158, s82, v158
  v_mul_f32 v159, s82, v159
  v_cvt_pk_bf16_f32 v35, v158, v159
  v_mfma_f32_16x16x32_bf16 v[64:67], a[136:139], v[8:11], v[64:67]
  v_lshlrev_b32 v152, 16, v36
  v_and_b32 v153, 0xffff0000, v36
  v_mul_f32 v152, s82, v152
  v_mul_f32 v153, s82, v153
  v_cvt_pk_bf16_f32 v36, v152, v153
  v_lshlrev_b32 v154, 16, v37
  v_and_b32 v155, 0xffff0000, v37
  v_mul_f32 v154, s82, v154
  v_mul_f32 v155, s82, v155
  v_cvt_pk_bf16_f32 v37, v154, v155
  v_mfma_f32_16x16x32_bf16 v[64:67], a[140:143], v[12:15], v[64:67]
  v_lshlrev_b32 v156, 16, v38
  v_and_b32 v157, 0xffff0000, v38
  v_mul_f32 v156, s82, v156
  v_mul_f32 v157, s82, v157
  v_cvt_pk_bf16_f32 v38, v156, v157
  v_lshlrev_b32 v158, 16, v39
  v_and_b32 v159, 0xffff0000, v39
  v_mul_f32 v158, s82, v158
  v_mul_f32 v159, s82, v159
  v_cvt_pk_bf16_f32 v39, v158, v159
  v_mfma_f32_16x16x32_bf16 v[68:71], a[144:147], v[0:3], v[212:215]
  v_lshlrev_b32 v152, 16, v40
  v_and_b32 v153, 0xffff0000, v40
  v_mul_f32 v152, s82, v152
  v_mul_f32 v153, s82, v153
  v_cvt_pk_bf16_f32 v40, v152, v153
  v_lshlrev_b32 v154, 16, v41
  v_and_b32 v155, 0xffff0000, v41
  v_mul_f32 v154, s82, v154
  v_mul_f32 v155, s82, v155
  v_cvt_pk_bf16_f32 v41, v154, v155
  v_mfma_f32_16x16x32_bf16 v[68:71], a[148:151], v[4:7], v[68:71]
  v_lshlrev_b32 v156, 16, v42
  v_and_b32 v157, 0xffff0000, v42
  v_mul_f32 v156, s82, v156
  v_mul_f32 v157, s82, v157
  v_cvt_pk_bf16_f32 v42, v156, v157
  v_lshlrev_b32 v158, 16, v43
  v_and_b32 v159, 0xffff0000, v43
  v_mul_f32 v158, s82, v158
  v_mul_f32 v159, s82, v159
  v_cvt_pk_bf16_f32 v43, v158, v159
  v_mfma_f32_16x16x32_bf16 v[68:71], a[152:155], v[8:11], v[68:71]
  v_lshlrev_b32 v152, 16, v44
  v_and_b32 v153, 0xffff0000, v44
  v_mul_f32 v152, s82, v152
  v_mul_f32 v153, s82, v153
  v_cvt_pk_bf16_f32 v44, v152, v153
  v_lshlrev_b32 v154, 16, v45
  v_and_b32 v155, 0xffff0000, v45
  v_mul_f32 v154, s82, v154
  v_mul_f32 v155, s82, v155
  v_cvt_pk_bf16_f32 v45, v154, v155
  v_mfma_f32_16x16x32_bf16 v[68:71], a[156:159], v[12:15], v[68:71]
  v_lshlrev_b32 v156, 16, v46
  v_and_b32 v157, 0xffff0000, v46
  v_mul_f32 v156, s82, v156
  v_mul_f32 v157, s82, v157
  v_cvt_pk_bf16_f32 v46, v156, v157
  v_lshlrev_b32 v158, 16, v47
  v_and_b32 v159, 0xffff0000, v47
  v_mul_f32 v158, s82, v158
  v_mul_f32 v159, s82, v159
  v_cvt_pk_bf16_f32 v47, v158, v159
  v_mfma_f32_16x16x32_bf16 v[72:75], a[128:131], v[16:19], v[208:211]
  v_lshlrev_b32 v152, 16, v48
  v_and_b32 v153, 0xffff0000, v48
  v_mul_f32 v152, s82, v152
  v_mul_f32 v153, s82, v153
  v_cvt_pk_bf16_f32 v48, v152, v153
  v_lshlrev_b32 v154, 16, v49
  v_and_b32 v155, 0xffff0000, v49
  v_mul_f32 v154, s82, v154
  v_mul_f32 v155, s82, v155
  v_cvt_pk_bf16_f32 v49, v154, v155
  v_mfma_f32_16x16x32_bf16 v[72:75], a[132:135], v[20:23], v[72:75]
  v_lshlrev_b32 v156, 16, v50
  v_and_b32 v157, 0xffff0000, v50
  v_mul_f32 v156, s82, v156
  v_mul_f32 v157, s82, v157
  v_cvt_pk_bf16_f32 v50, v156, v157
  v_lshlrev_b32 v158, 16, v51
  v_and_b32 v159, 0xffff0000, v51
  v_mul_f32 v158, s82, v158
  v_mul_f32 v159, s82, v159
  v_cvt_pk_bf16_f32 v51, v158, v159
  v_mfma_f32_16x16x32_bf16 v[72:75], a[136:139], v[24:27], v[72:75]
  v_lshlrev_b32 v152, 16, v52
  v_and_b32 v153, 0xffff0000, v52
  v_mul_f32 v152, s82, v152
  v_mul_f32 v153, s82, v153
  v_cvt_pk_bf16_f32 v52, v152, v153
  v_lshlrev_b32 v154, 16, v53
  v_and_b32 v155, 0xffff0000, v53
  v_mul_f32 v154, s82, v154
  v_mul_f32 v155, s82, v155
  v_cvt_pk_bf16_f32 v53, v154, v155
  v_mfma_f32_16x16x32_bf16 v[72:75], a[140:143], v[28:31], v[72:75]
  v_lshlrev_b32 v156, 16, v54
  v_and_b32 v157, 0xffff0000, v54
  v_mul_f32 v156, s82, v156
  v_mul_f32 v157, s82, v157
  v_cvt_pk_bf16_f32 v54, v156, v157
  v_lshlrev_b32 v158, 16, v55
  v_and_b32 v159, 0xffff0000, v55
  v_mul_f32 v158, s82, v158
  v_mul_f32 v159, s82, v159
  v_cvt_pk_bf16_f32 v55, v158, v159
  v_mfma_f32_16x16x32_bf16 v[76:79], a[144:147], v[16:19], v[212:215]
  v_lshlrev_b32 v152, 16, v56
  v_and_b32 v153, 0xffff0000, v56
  v_mul_f32 v152, s82, v152
  v_mul_f32 v153, s82, v153
  v_cvt_pk_bf16_f32 v56, v152, v153
  v_lshlrev_b32 v154, 16, v57
  v_and_b32 v155, 0xffff0000, v57
  v_mul_f32 v154, s82, v154
  v_mul_f32 v155, s82, v155
  v_cvt_pk_bf16_f32 v57, v154, v155
  v_mfma_f32_16x16x32_bf16 v[76:79], a[148:151], v[20:23], v[76:79]
  v_lshlrev_b32 v156, 16, v58
  v_and_b32 v157, 0xffff0000, v58
  v_mul_f32 v156, s82, v156
  v_mul_f32 v157, s82, v157
  v_cvt_pk_bf16_f32 v58, v156, v157
  v_lshlrev_b32 v158, 16, v59
  v_and_b32 v159, 0xffff0000, v59
  v_mul_f32 v158, s82, v158
  v_mul_f32 v159, s82, v159
  v_cvt_pk_bf16_f32 v59, v158, v159
  v_mfma_f32_16x16x32_bf16 v[76:79], a[152:155], v[24:27], v[76:79]
  v_lshlrev_b32 v152, 16, v60
  v_and_b32 v153, 0xffff0000, v60
  v_mul_f32 v152, s82, v152
  v_mul_f32 v153, s82, v153
  v_cvt_pk_bf16_f32 v60, v152, v153
  v_lshlrev_b32 v154, 16, v61
  v_and_b32 v155, 0xffff0000, v61
  v_mul_f32 v154, s82, v154
  v_mul_f32 v155, s82, v155
  v_cvt_pk_bf16_f32 v61, v154, v155
  v_mfma_f32_16x16x32_bf16 v[76:79], a[156:159], v[28:31], v[76:79]
  v_lshlrev_b32 v156, 16, v62
  v_and_b32 v157, 0xffff0000, v62
  v_mul_f32 v156, s82, v156
  v_mul_f32 v157, s82, v157
  v_cvt_pk_bf16_f32 v62, v156, v157
  v_lshlrev_b32 v158, 16, v63
  v_and_b32 v159, 0xffff0000, v63
  v_mul_f32 v158, s82, v158
  v_mul_f32 v159, s82, v159
  v_cvt_pk_bf16_f32 v63, v158, v159
  s_waitcnt lgkmcnt(0)
  v_readlane_b32 s78, v144, 3
  s_nop 2
  s_add_u32 m0, s79, 49152
  s_nop 0
  buffer_load_dwordx4 v140, s[52:55], s78 offen offset:0 nt lds
  buffer_load_dwordx4 v141, s[52:55], s78 offen offset:1024 nt lds
  buffer_load_dwordx4 v142, s[52:55], s78 offen offset:2048 nt lds
  buffer_load_dwordx4 v143, s[52:55], s78 offen offset:3072 nt lds
  s_nop 0
  v_mfma_f32_16x16x32_bf16 v[80:83], a[128:131], v[32:35], v[208:211]
  v_mfma_f32_16x16x32_bf16 v[80:83], a[132:135], v[36:39], v[80:83]
  v_mfma_f32_16x16x32_bf16 v[80:83], a[136:139], v[40:43], v[80:83]
  v_max3_f32 v178, v64, v65, v66
  v_max3_f32 v178, v178, v67, v68
  v_max3_f32 v178, v178, v69, v70
  v_max_f32 v178, v178, v71
  v_mov_b32 v194, v178
  s_nop 1
  v_mfma_f32_16x16x32_bf16 v[80:83], a[140:143], v[44:47], v[80:83]
  v_permlane32_swap_b32 v178, v194
  s_nop 1
  v_max_f32 v178, v178, v194
  v_mov_b32 v194, v178
  s_nop 1
  v_permlane16_swap_b32 v178, v194
  v_mfma_f32_16x16x32_bf16 v[84:87], a[144:147], v[32:35], v[212:215]
  s_nop 1
  v_max_f32 v178, v178, v194
  v_add_f32 v178, 0x40e00000, v178
  v_sub_f32 v64, v64, v178
  v_sub_f32 v65, v65, v178
  v_sub_f32 v66, v66, v178
  v_mfma_f32_16x16x32_bf16 v[84:87], a[148:151], v[36:39], v[84:87]
  v_sub_f32 v67, v67, v178
  v_sub_f32 v68, v68, v178
  v_sub_f32 v69, v69, v178
  v_sub_f32 v70, v70, v178
  v_sub_f32 v71, v71, v178
  v_sub_f32 v96, 0, v178
  v_mfma_f32_16x16x32_bf16 v[84:87], a[152:155], v[40:43], v[84:87]
  v_sub_f32 v97, 0, v178
  v_sub_f32 v98, 0, v178
  v_sub_f32 v99, 0, v178
  v_max3_f32 v179, v72, v73, v74
  v_max3_f32 v179, v179, v75, v76
  v_max3_f32 v179, v179, v77, v78
  v_mfma_f32_16x16x32_bf16 v[84:87], a[156:159], v[44:47], v[84:87]
  v_max_f32 v179, v179, v79
  v_mov_b32 v194, v179
  s_nop 1
  v_permlane32_swap_b32 v179, v194
  s_nop 1
  v_max_f32 v179, v179, v194
  v_mfma_f32_16x16x32_bf16 v[88:91], a[128:131], v[48:51], v[208:211]
  v_mov_b32 v194, v179
  s_nop 1
  v_permlane16_swap_b32 v179, v194
  s_nop 1
  v_max_f32 v179, v179, v194
  v_add_f32 v179, 0x40e00000, v179
  v_mfma_f32_16x16x32_bf16 v[88:91], a[132:135], v[52:55], v[88:91]
  v_sub_f32 v72, v72, v179
  v_sub_f32 v73, v73, v179
  v_sub_f32 v74, v74, v179
  v_sub_f32 v75, v75, v179
  v_sub_f32 v76, v76, v179
  v_sub_f32 v77, v77, v179
  v_mfma_f32_16x16x32_bf16 v[88:91], a[136:139], v[56:59], v[88:91]
  v_sub_f32 v78, v78, v179
  v_sub_f32 v79, v79, v179
  v_sub_f32 v100, 0, v179
  v_sub_f32 v101, 0, v179
  v_sub_f32 v102, 0, v179
  v_sub_f32 v103, 0, v179
  v_mfma_f32_16x16x32_bf16 v[88:91], a[140:143], v[60:63], v[88:91]
  v_exp_f32 v162, v64
  v_exp_f32 v163, v65
  v_exp_f32 v164, v66
  v_cvt_pk_bf16_f32 v112, v162, v163
  v_exp_f32 v165, v67
  v_exp_f32 v166, v68
  v_mfma_f32_16x16x32_bf16 v[92:95], a[144:147], v[48:51], v[212:215]
  v_cvt_pk_bf16_f32 v113, v164, v165
  v_exp_f32 v167, v69
  v_exp_f32 v168, v70
  v_cvt_pk_bf16_f32 v114, v166, v167
  v_exp_f32 v169, v71
  v_exp_f32 v162, v72
  v_mfma_f32_16x16x32_bf16 v[92:95], a[148:151], v[52:55], v[92:95]
  v_cvt_pk_bf16_f32 v115, v168, v169
  v_exp_f32 v163, v73
  v_or3_b32 v170, v112, v113, v114
  v_exp_f32 v164, v74
  v_cvt_pk_bf16_f32 v116, v162, v163
  v_exp_f32 v165, v75
  v_mfma_f32_16x16x32_bf16 v[92:95], a[152:155], v[56:59], v[92:95]
  v_exp_f32 v166, v76
  v_cvt_pk_bf16_f32 v117, v164, v165
  v_exp_f32 v167, v77
  v_or3_b32 v170, v170, v115, v116
  v_exp_f32 v168, v78
  v_cvt_pk_bf16_f32 v118, v166, v167
  v_mfma_f32_16x16x32_bf16 v[92:95], a[156:159], v[60:63], v[92:95]
  v_exp_f32 v169, v79
  s_nop 0
  v_cvt_pk_bf16_f32 v119, v168, v169
  v_or3_b32 v170, v170, v117, v118
  v_bitop3_b32 v170, v170, v119, s80 bitop3:0xa8
  v_cmp_ne_u32 vcc, 0, v170
  s_waitcnt vmcnt(8)
  s_barrier
  ds_read_b128 a[128:131], v128 offset:16384
  ds_read_b128 a[132:135], v129 offset:16384
  ds_read_b128 a[136:139], v130 offset:16384
  ds_read_b128 a[140:143], v131 offset:16384
  ds_read_b128 a[144:147], v128 offset:20480
  ds_read_b128 a[148:151], v129 offset:20480
  ds_read_b128 a[152:155], v130 offset:20480
  ds_read_b128 a[156:159], v131 offset:20480
  v_readlane_b32 s78, v144, 4
  s_nop 2
  s_add_u32 m0, s79, 0
  s_nop 0
  buffer_load_dwordx4 v140, s[52:55], s78 offen offset:0 nt lds
  buffer_load_dwordx4 v141, s[52:55], s78 offen offset:1024 nt lds
  buffer_load_dwordx4 v142, s[52:55], s78 offen offset:2048 nt lds
  buffer_load_dwordx4 v143, s[52:55], s78 offen offset:3072 nt lds
  s_add_u32 s76, s76, 1
  buffer_load_dword v201, v206, s[60:63], s100 offen sc1
  v_mfma_f32_16x16x32_bf16 a[0:3], a[160:163], v[112:115], a[0:3]
  v_max3_f32 v180, v80, v81, v82
  v_max3_f32 v180, v180, v83, v84
  v_max3_f32 v180, v180, v85, v86
  v_max_f32 v180, v180, v87
  v_mfma_f32_16x16x32_bf16 a[32:35], a[160:163], v[116:119], a[32:35]
  v_mov_b32 v194, v180
  s_nop 1
  v_permlane32_swap_b32 v180, v194
  s_nop 1
  v_mfma_f32_16x16x32_bf16 a[4:7], a[164:167], v[112:115], a[4:7]
  v_max_f32 v180, v180, v194
  v_mov_b32 v194, v180
  s_nop 1
  v_permlane16_swap_b32 v180, v194
  v_mfma_f32_16x16x32_bf16 a[36:39], a[164:167], v[116:119], a[36:39]
  s_nop 1
  v_max_f32 v180, v180, v194
  v_add_f32 v180, 0x40e00000, v180
  v_sub_f32 v80, v80, v180
  v_mfma_f32_16x16x32_bf16 a[8:11], a[168:171], v[112:115], a[8:11]
  v_sub_f32 v81, v81, v180
  v_sub_f32 v82, v82, v180
  v_sub_f32 v83, v83, v180
  v_sub_f32 v84, v84, v180
  v_mfma_f32_16x16x32_bf16 a[40:43], a[168:171], v[116:119], a[40:43]
  v_sub_f32 v85, v85, v180
  v_sub_f32 v86, v86, v180
  v_sub_f32 v87, v87, v180
  v_sub_f32 v104, 0, v180
  v_mfma_f32_16x16x32_bf16 a[12:15], a[172:175], v[112:115], a[12:15]
  v_sub_f32 v105, 0, v180
  v_sub_f32 v106, 0, v180
  v_sub_f32 v107, 0, v180
  v_max3_f32 v181, v88, v89, v90
  v_mfma_f32_16x16x32_bf16 a[44:47], a[172:175], v[116:119], a[44:47]
  v_max3_f32 v181, v181, v91, v92
  v_max3_f32 v181, v181, v93, v94
  v_max_f32 v181, v181, v95
  v_mov_b32 v194, v181
  v_mfma_f32_16x16x32_bf16 a[16:19], a[176:179], v[112:115], a[16:19]
  s_nop 1
  v_permlane32_swap_b32 v181, v194
  s_nop 1
  v_max_f32 v181, v181, v194
  v_mfma_f32_16x16x32_bf16 a[48:51], a[176:179], v[116:119], a[48:51]
  v_mov_b32 v194, v181
  s_nop 1
  v_permlane16_swap_b32 v181, v194
  s_nop 1
  v_mfma_f32_16x16x32_bf16 a[20:23], a[180:183], v[112:115], a[20:23]
  v_max_f32 v181, v181, v194
  v_add_f32 v181, 0x40e00000, v181
  v_sub_f32 v88, v88, v181
  v_sub_f32 v89, v89, v181
  v_mfma_f32_16x16x32_bf16 a[52:55], a[180:183], v[116:119], a[52:55]
  v_sub_f32 v90, v90, v181
  v_sub_f32 v91, v91, v181
  v_sub_f32 v92, v92, v181
  v_sub_f32 v93, v93, v181
  v_mfma_f32_16x16x32_bf16 a[24:27], a[184:187], v[112:115], a[24:27]
  v_sub_f32 v94, v94, v181
  v_sub_f32 v95, v95, v181
  v_sub_f32 v108, 0, v181
  v_sub_f32 v109, 0, v181
  v_mfma_f32_16x16x32_bf16 a[56:59], a[184:187], v[116:119], a[56:59]
  v_sub_f32 v110, 0, v181
  v_sub_f32 v111, 0, v181
  v_exp_f32 v152, v80
  v_exp_f32 v153, v81
  v_mfma_f32_16x16x32_bf16 a[28:31], a[188:191], v[112:115], a[28:31]
  v_exp_f32 v154, v82
  v_exp_f32 v155, v83
  v_exp_f32 v156, v84
  v_exp_f32 v157, v85
  v_mfma_f32_16x16x32_bf16 a[60:63], a[188:191], v[116:119], a[60:63]
  v_cvt_pk_bf16_f32 v120, v152, v153
  v_exp_f32 v158, v86
  v_exp_f32 v159, v87
  v_cvt_pk_bf16_f32 v121, v154, v155
  v_mfma_f32_16x16x32_bf16 v[224:227], a[192:195], v[112:115], v[224:227]
  v_cvt_pk_bf16_f32 v122, v156, v157
  v_exp_f32 v152, v88
  v_cvt_pk_bf16_f32 v123, v158, v159
  v_or3_b32 v172, v120, v121, v122
  v_mfma_f32_16x16x32_bf16 v[228:231], a[192:195], v[116:119], v[228:231]
  v_exp_f32 v153, v89
  v_exp_f32 v154, v90
  v_exp_f32 v155, v91
  v_exp_f32 v156, v92
  v_cvt_pk_bf16_f32 v124, v152, v153
  s_waitcnt vmcnt(1)
  s_cmp_ge_u32 s76, s77
  s_cbranch_scc1 L_drain
  .p2align 6
L_loop:
  s_waitcnt lgkmcnt(0)
  v_mfma_f32_16x16x32_bf16 v[64:67], a[128:131], v[0:3], v[96:99]
  v_exp_f32 v157, v93
  v_mfma_f32_16x16x32_bf16 v[64:67], a[132:135], v[4:7], v[64:67]
  v_cvt_pk_bf16_f32 v125, v154, v155
  v_or3_b32 v172, v172, v123, v124
  v_mfma_f32_16x16x32_bf16 v[64:67], a[136:139], v[8:11], v[64:67]
  v_exp_f32 v158, v94
  v_mfma_f32_16x16x32_bf16 v[64:67], a[140:143], v[12:15], v[64:67]
  v_exp_f32 v159, v95
  v_mfma_f32_16x16x32_bf16 v[68:71], a[144:147], v[0:3], v[96:99]
  v_cvt_pk_bf16_f32 v126, v156, v157
  v_cvt_pk_bf16_f32 v127, v158, v159
  v_mfma_f32_16x16x32_bf16 v[68:71], a[148:151], v[4:7], v[68:71]
  v_or3_b32 v172, v172, v125, v126
  v_bitop3_b32 v172, v172, v127, s80 bitop3:0xa8
  v_cmp_ne_u32 vcc, 0, v172
  v_mfma_f32_16x16x32_bf16 v[68:71], a[152:155], v[8:11], v[68:71]
  v_exp_f32 v162, v64
  v_mfma_f32_16x16x32_bf16 v[68:71], a[156:159], v[12:15], v[68:71]
  v_exp_f32 v163, v65
  v_mfma_f32_16x16x32_bf16 v[72:75], a[128:131], v[16:19], v[100:103]
  s_cbranch_vccnz L_stub_b1
L_back_b1:
  v_mfma_f32_16x16x32_bf16 v[72:75], a[132:135], v[20:23], v[72:75]
  v_exp_f32 v164, v66
  v_mfma_f32_16x16x32_bf16 v[72:75], a[136:139], v[24:27], v[72:75]
  v_cvt_pk_bf16_f32 v112, v162, v163
  v_mfma_f32_16x16x32_bf16 v[72:75], a[140:143], v[28:31], v[72:75]
  v_exp_f32 v165, v67
  v_mfma_f32_16x16x32_bf16 v[76:79], a[144:147], v[16:19], v[100:103]
  v_exp_f32 v166, v68
  v_mfma_f32_16x16x32_bf16 v[76:79], a[148:151], v[20:23], v[76:79]
  v_cvt_pk_bf16_f32 v113, v164, v165
  v_mfma_f32_16x16x32_bf16 v[76:79], a[152:155], v[24:27], v[76:79]
  v_exp_f32 v167, v69
  v_mfma_f32_16x16x32_bf16 v[76:79], a[156:159], v[28:31], v[76:79]
  v_exp_f32 v168, v70
  v_mfma_f32_16x16x32_bf16 a[64:67], a[160:163], v[120:123], a[64:67]
  v_cvt_pk_bf16_f32 v114, v166, v167
  v_mfma_f32_16x16x32_bf16 a[96:99], a[160:163], v[124:127], a[96:99]
  v_exp_f32 v169, v71
  v_mfma_f32_16x16x32_bf16 a[68:71], a[164:167], v[120:123], a[68:71]
  ds_read_b64_tr_b16 a[160:161], v132 offset:24576
  ds_read_b64_tr_b16 a[162:163], v132 offset:28672
  v_mfma_f32_16x16x32_bf16 a[100:103], a[164:167], v[124:127], a[100:103]
  v_cvt_pk_bf16_f32 v115, v168, v169
  v_mfma_f32_16x16x32_bf16 a[72:75], a[168:171], v[120:123], a[72:75]
  ds_read_b64_tr_b16 a[164:165], v133 offset:24576
  ds_read_b64_tr_b16 a[166:167], v133 offset:28672
  v_mfma_f32_16x16x32_bf16 a[104:107], a[168:171], v[124:127], a[104:107]
  v_exp_f32 v162, v72
  v_mfma_f32_16x16x32_bf16 a[76:79], a[172:175], v[120:123], a[76:79]
  ds_read_b64_tr_b16 a[168:169], v134 offset:24576
  ds_read_b64_tr_b16 a[170:171], v134 offset:28672
  v_mfma_f32_16x16x32_bf16 a[108:111], a[172:175], v[124:127], a[108:111]
  v_exp_f32 v163, v73
  v_mfma_f32_16x16x32_bf16 a[80:83], a[176:179], v[120:123], a[80:83]
  ds_read_b64_tr_b16 a[172:173], v135 offset:24576
  ds_read_b64_tr_b16 a[174:175], v135 offset:28672
  v_mfma_f32_16x16x32_bf16 a[112:115], a[176:179], v[124:127], a[112:115]
  v_exp_f32 v164, v74
  v_mfma_f32_16x16x32_bf16 a[84:87], a[180:183], v[120:123], a[84:87]
  ds_read_b64_tr_b16 a[176:177], v136 offset:24576
  ds_read_b64_tr_b16 a[178:179], v136 offset:28672
  v_mfma_f32_16x16x32_bf16 a[116:119], a[180:183], v[124:127], a[116:119]
  v_exp_f32 v165, v75
  v_mfma_f32_16x16x32_bf16 a[88:91], a[184:187], v[120:123], a[88:91]
  ds_read_b64_tr_b16 a[180:181], v137 offset:24576
  ds_read_b64_tr_b16 a[182:183], v137 offset:28672
  v_mfma_f32_16x16x32_bf16 a[120:123], a[184:187], v[124:127], a[120:123]
  v_or3_b32 v170, v112, v113, v114
  v_cvt_pk_bf16_f32 v116, v162, v163
  v_mfma_f32_16x16x32_bf16 a[92:95], a[188:191], v[120:123], a[92:95]
  ds_read_b64_tr_b16 a[184:185], v138 offset:24576
  ds_read_b64_tr_b16 a[186:187], v138 offset:28672
  v_mfma_f32_16x16x32_bf16 a[124:127], a[188:191], v[124:127], a[124:127]
  v_exp_f32 v166, v76
  v_mfma_f32_16x16x32_bf16 v[232:235], a[192:195], v[120:123], v[232:235]
  ds_read_b64_tr_b16 a[188:189], v139 offset:24576
  ds_read_b64_tr_b16 a[190:191], v139 offset:28672
  v_mfma_f32_16x16x32_bf16 v[236:239], a[192:195], v[124:127], v[236:239]
  v_exp_f32 v167, v77
  v_mfma_f32_16x16x32_bf16 v[80:83], a[128:131], v[32:35], v[104:107]
  v_cvt_pk_bf16_f32 v117, v164, v165
  v_or3_b32 v170, v170, v115, v116
  v_mfma_f32_16x16x32_bf16 v[80:83], a[132:135], v[36:39], v[80:83]
  v_exp_f32 v168, v78
  v_mfma_f32_16x16x32_bf16 v[80:83], a[136:139], v[40:43], v[80:83]
  v_exp_f32 v169, v79
  v_mfma_f32_16x16x32_bf16 v[80:83], a[140:143], v[44:47], v[80:83]
  v_cvt_pk_bf16_f32 v118, v166, v167
  v_cvt_pk_bf16_f32 v119, v168, v169
  v_mfma_f32_16x16x32_bf16 v[84:87], a[144:147], v[32:35], v[104:107]
  v_readlane_b32 s78, v144, s76
  v_or3_b32 v170, v170, v117, v118
  v_mfma_f32_16x16x32_bf16 v[84:87], a[148:151], v[36:39], v[84:87]
  v_bitop3_b32 v170, v170, v119, s80 bitop3:0xa8
  v_cmp_ne_u32 vcc, 0, v170
  v_mfma_f32_16x16x32_bf16 v[84:87], a[152:155], v[40:43], v[84:87]
  s_waitcnt vmcnt(8) lgkmcnt(0)
  s_barrier
  v_mfma_f32_16x16x32_bf16 v[84:87], a[156:159], v[44:47], v[84:87]
  v_exp_f32 v152, v80
  v_mfma_f32_16x16x32_bf16 v[88:91], a[128:131], v[48:51], v[108:111]
  s_add_u32 m0, s79, 16384
  s_cbranch_vccnz L_stub_a1
L_back_a1:
  v_mfma_f32_16x16x32_bf16 v[88:91], a[132:135], v[52:55], v[88:91]
  v_exp_f32 v153, v81
  v_mfma_f32_16x16x32_bf16 v[88:91], a[136:139], v[56:59], v[88:91]
  v_exp_f32 v154, v82
  v_mfma_f32_16x16x32_bf16 v[88:91], a[140:143], v[60:63], v[88:91]
  v_exp_f32 v155, v83
  v_mfma_f32_16x16x32_bf16 v[92:95], a[144:147], v[48:51], v[108:111]
  ds_read_b128 a[128:131], v128 offset:32768
  v_mfma_f32_16x16x32_bf16 v[92:95], a[148:151], v[52:55], v[92:95]
  v_exp_f32 v156, v84
  v_mfma_f32_16x16x32_bf16 v[92:95], a[152:155], v[56:59], v[92:95]
  ds_read_b128 a[132:135], v129 offset:32768
  v_mfma_f32_16x16x32_bf16 v[92:95], a[156:159], v[60:63], v[92:95]
  v_exp_f32 v157, v85
  v_mfma_f32_16x16x32_bf16 a[0:3], a[160:163], v[112:115], a[0:3]
  ds_read_b128 a[136:139], v130 offset:32768
  v_cvt_pk_bf16_f32 v120, v152, v153
  v_mfma_f32_16x16x32_bf16 a[32:35], a[160:163], v[116:119], a[32:35]
  buffer_load_dwordx4 v140, s[52:55], s78 offen offset:0 nt lds
  v_mfma_f32_16x16x32_bf16 a[4:7], a[164:167], v[112:115], a[4:7]
  ds_read_b128 a[140:143], v131 offset:32768
  v_exp_f32 v158, v86
  v_mfma_f32_16x16x32_bf16 a[36:39], a[164:167], v[116:119], a[36:39]
  v_exp_f32 v159, v87
  v_mfma_f32_16x16x32_bf16 a[8:11], a[168:171], v[112:115], a[8:11]
  ds_read_b128 a[144:147], v128 offset:36864
  v_cvt_pk_bf16_f32 v121, v154, v155
  v_mfma_f32_16x16x32_bf16 a[40:43], a[168:171], v[116:119], a[40:43]
  buffer_load_dwordx4 v141, s[52:55], s78 offen offset:1024 nt lds
  v_mfma_f32_16x16x32_bf16 a[12:15], a[172:175], v[112:115], a[12:15]
  ds_read_b128 a[148:151], v129 offset:36864
  v_cvt_pk_bf16_f32 v122, v156, v157
  v_mfma_f32_16x16x32_bf16 a[44:47], a[172:175], v[116:119], a[44:47]
  v_exp_f32 v152, v88
  v_mfma_f32_16x16x32_bf16 a[16:19], a[176:179], v[112:115], a[16:19]
  ds_read_b128 a[152:155], v130 offset:36864
  v_cvt_pk_bf16_f32 v123, v158, v159
  v_mfma_f32_16x16x32_bf16 a[48:51], a[176:179], v[116:119], a[48:51]
  buffer_load_dwordx4 v142, s[52:55], s78 offen offset:2048 nt lds
  v_mfma_f32_16x16x32_bf16 a[20:23], a[180:183], v[112:115], a[20:23]
  ds_read_b128 a[156:159], v131 offset:36864
  v_or3_b32 v172, v120, v121, v122
  v_mfma_f32_16x16x32_bf16 a[52:55], a[180:183], v[116:119], a[52:55]
  v_exp_f32 v153, v89
  v_mfma_f32_16x16x32_bf16 a[24:27], a[184:187], v[112:115], a[24:27]
  v_exp_f32 v154, v90
  v_mfma_f32_16x16x32_bf16 a[56:59], a[184:187], v[116:119], a[56:59]
  buffer_load_dwordx4 v143, s[52:55], s78 offen offset:3072 nt lds
  v_mfma_f32_16x16x32_bf16 a[28:31], a[188:191], v[112:115], a[28:31]
  v_exp_f32 v155, v91
  v_mfma_f32_16x16x32_bf16 a[60:63], a[188:191], v[116:119], a[60:63]
  v_exp_f32 v156, v92
  v_mfma_f32_16x16x32_bf16 v[224:227], a[192:195], v[112:115], v[224:227]
  v_cvt_pk_bf16_f32 v124, v152, v153
  s_add_u32 s76, s76, 1
  v_mfma_f32_16x16x32_bf16 v[228:231], a[192:195], v[116:119], v[228:231]
  s_cmp_ge_u32 s76, s77
  s_cbranch_scc1 L_drain
  s_waitcnt lgkmcnt(0)
  v_mfma_f32_16x16x32_bf16 v[64:67], a[128:131], v[0:3], v[96:99]
  v_exp_f32 v157, v93
  v_mfma_f32_16x16x32_bf16 v[64:67], a[132:135], v[4:7], v[64:67]
  v_cvt_pk_bf16_f32 v125, v154, v155
  v_or3_b32 v172, v172, v123, v124
  v_mfma_f32_16x16x32_bf16 v[64:67], a[136:139], v[8:11], v[64:67]
  v_exp_f32 v158, v94
  v_mfma_f32_16x16x32_bf16 v[64:67], a[140:143], v[12:15], v[64:67]
  v_exp_f32 v159, v95
  v_mfma_f32_16x16x32_bf16 v[68:71], a[144:147], v[0:3], v[96:99]
  v_cvt_pk_bf16_f32 v126, v156, v157
  v_cvt_pk_bf16_f32 v127, v158, v159
  v_mfma_f32_16x16x32_bf16 v[68:71], a[148:151], v[4:7], v[68:71]
  v_or3_b32 v172, v172, v125, v126
  v_bitop3_b32 v172, v172, v127, s80 bitop3:0xa8
  v_cmp_ne_u32 vcc, 0, v172
  v_mfma_f32_16x16x32_bf16 v[68:71], a[152:155], v[8:11], v[68:71]
  v_exp_f32 v162, v64
  v_mfma_f32_16x16x32_bf16 v[68:71], a[156:159], v[12:15], v[68:71]
  v_exp_f32 v163, v65
  v_mfma_f32_16x16x32_bf16 v[72:75], a[128:131], v[16:19], v[100:103]
  s_cbranch_vccnz L_stub_b2
L_back_b2:
  v_mfma_f32_16x16x32_bf16 v[72:75], a[132:135], v[20:23], v[72:75]
  v_exp_f32 v164, v66
  v_mfma_f32_16x16x32_bf16 v[72:75], a[136:139], v[24:27], v[72:75]
  v_cvt_pk_bf16_f32 v112, v162, v163
  v_mfma_f32_16x16x32_bf16 v[72:75], a[140:143], v[28:31], v[72:75]
  v_exp_f32 v165, v67
  v_mfma_f32_16x16x32_bf16 v[76:79], a[144:147], v[16:19], v[100:103]
  v_exp_f32 v166, v68
  v_mfma_f32_16x16x32_bf16 v[76:79], a[148:151], v[20:23], v[76:79]
  v_cvt_pk_bf16_f32 v113, v164, v165
  v_mfma_f32_16x16x32_bf16 v[76:79], a[152:155], v[24:27], v[76:79]
  v_exp_f32 v167, v69
  v_mfma_f32_16x16x32_bf16 v[76:79], a[156:159], v[28:31], v[76:79]
  v_exp_f32 v168, v70
  v_mfma_f32_16x16x32_bf16 a[64:67], a[160:163], v[120:123], a[64:67]
  v_cvt_pk_bf16_f32 v114, v166, v167
  v_mfma_f32_16x16x32_bf16 a[96:99], a[160:163], v[124:127], a[96:99]
  v_exp_f32 v169, v71
  v_mfma_f32_16x16x32_bf16 a[68:71], a[164:167], v[120:123], a[68:71]
  ds_read_b64_tr_b16 a[160:161], v132 offset:40960
  ds_read_b64_tr_b16 a[162:163], v132 offset:45056
  v_mfma_f32_16x16x32_bf16 a[100:103], a[164:167], v[124:127], a[100:103]
  v_cvt_pk_bf16_f32 v115, v168, v169
  v_mfma_f32_16x16x32_bf16 a[72:75], a[168:171], v[120:123], a[72:75]
  ds_read_b64_tr_b16 a[164:165], v133 offset:40960
  ds_read_b64_tr_b16 a[166:167], v133 offset:45056
  v_mfma_f32_16x16x32_bf16 a[104:107], a[168:171], v[124:127], a[104:107]
  v_exp_f32 v162, v72
  v_mfma_f32_16x16x32_bf16 a[76:79], a[172:175], v[120:123], a[76:79]
  ds_read_b64_tr_b16 a[168:169], v134 offset:40960
  ds_read_b64_tr_b16 a[170:171], v134 offset:45056
  v_mfma_f32_16x16x32_bf16 a[108:111], a[172:175], v[124:127], a[108:111]
  v_exp_f32 v163, v73
  v_mfma_f32_16x16x32_bf16 a[80:83], a[176:179], v[120:123], a[80:83]
  ds_read_b64_tr_b16 a[172:173], v135 offset:40960
  ds_read_b64_tr_b16 a[174:175], v135 offset:45056
  v_mfma_f32_16x16x32_bf16 a[112:115], a[176:179], v[124:127], a[112:115]
  v_exp_f32 v164, v74
  v_mfma_f32_16x16x32_bf16 a[84:87], a[180:183], v[120:123], a[84:87]
  ds_read_b64_tr_b16 a[176:177], v136 offset:40960
  ds_read_b64_tr_b16 a[178:179], v136 offset:45056
  v_mfma_f32_16x16x32_bf16 a[116:119], a[180:183], v[124:127], a[116:119]
  v_exp_f32 v165, v75
  v_mfma_f32_16x16x32_bf16 a[88:91], a[184:187], v[120:123], a[88:91]
  ds_read_b64_tr_b16 a[180:181], v137 offset:40960
  ds_read_b64_tr_b16 a[182:183], v137 offset:45056
  v_mfma_f32_16x16x32_bf16 a[120:123], a[184:187], v[124:127], a[120:123]
  v_or3_b32 v170, v112, v113, v114
  v_cvt_pk_bf16_f32 v116, v162, v163
  v_mfma_f32_16x16x32_bf16 a[92:95], a[188:191], v[120:123], a[92:95]
  ds_read_b64_tr_b16 a[184:185], v138 offset:40960
  ds_read_b64_tr_b16 a[186:187], v138 offset:45056
  v_mfma_f32_16x16x32_bf16 a[124:127], a[188:191], v[124:127], a[124:127]
  v_exp_f32 v166, v76
  v_mfma_f32_16x16x32_bf16 v[232:235], a[192:195], v[120:123], v[232:235]
  ds_read_b64_tr_b16 a[188:189], v139 offset:40960
  ds_read_b64_tr_b16 a[190:191], v139 offset:45056
  v_mfma_f32_16x16x32_bf16 v[236:239], a[192:195], v[124:127], v[236:239]
  v_exp_f32 v167, v77
  v_mfma_f32_16x16x32_bf16 v[80:83], a[128:131], v[32:35], v[104:107]
  v_cvt_pk_bf16_f32 v117, v164, v165
  v_or3_b32 v170, v170, v115, v116
  v_mfma_f32_16x16x32_bf16 v[80:83], a[132:135], v[36:39], v[80:83]
  v_exp_f32 v168, v78
  v_mfma_f32_16x16x32_bf16 v[80:83], a[136:139], v[40:43], v[80:83]
  v_exp_f32 v169, v79
  v_mfma_f32_16x16x32_bf16 v[80:83], a[140:143], v[44:47], v[80:83]
  v_cvt_pk_bf16_f32 v118, v166, v167
  v_cvt_pk_bf16_f32 v119, v168, v169
  v_mfma_f32_16x16x32_bf16 v[84:87], a[144:147], v[32:35], v[104:107]
  v_readlane_b32 s78, v144, s76
  v_or3_b32 v170, v170, v117, v118
  v_mfma_f32_16x16x32_bf16 v[84:87], a[148:151], v[36:39], v[84:87]
  v_bitop3_b32 v170, v170, v119, s80 bitop3:0xa8
  v_cmp_ne_u32 vcc, 0, v170
  v_mfma_f32_16x16x32_bf16 v[84:87], a[152:155], v[40:43], v[84:87]
  s_waitcnt vmcnt(8) lgkmcnt(0)
  s_barrier
  v_mfma_f32_16x16x32_bf16 v[84:87], a[156:159], v[44:47], v[84:87]
  v_exp_f32 v152, v80
  v_mfma_f32_16x16x32_bf16 v[88:91], a[128:131], v[48:51], v[108:111]
  s_add_u32 m0, s79, 32768
  s_cbranch_vccnz L_stub_a2
L_back_a2:
  v_mfma_f32_16x16x32_bf16 v[88:91], a[132:135], v[52:55], v[88:91]
  v_exp_f32 v153, v81
  v_mfma_f32_16x16x32_bf16 v[88:91], a[136:139], v[56:59], v[88:91]
  v_exp_f32 v154, v82
  v_mfma_f32_16x16x32_bf16 v[88:91], a[140:143], v[60:63], v[88:91]
  v_exp_f32 v155, v83
  v_mfma_f32_16x16x32_bf16 v[92:95], a[144:147], v[48:51], v[108:111]
  ds_read_b128 a[128:131], v128 offset:49152
  v_mfma_f32_16x16x32_bf16 v[92:95], a[148:151], v[52:55], v[92:95]
  v_exp_f32 v156, v84
  v_mfma_f32_16x16x32_bf16 v[92:95], a[152:155], v[56:59], v[92:95]
  ds_read_b128 a[132:135], v129 offset:49152
  v_mfma_f32_16x16x32_bf16 v[92:95], a[156:159], v[60:63], v[92:95]
  v_exp_f32 v157, v85
  v_mfma_f32_16x16x32_bf16 a[0:3], a[160:163], v[112:115], a[0:3]
  ds_read_b128 a[136:139], v130 offset:49152
  v_cvt_pk_bf16_f32 v120, v152, v153
  v_mfma_f32_16x16x32_bf16 a[32:35], a[160:163], v[116:119], a[32:35]
  buffer_load_dwordx4 v140, s[52:55], s78 offen offset:0 nt lds
  v_mfma_f32_16x16x32_bf16 a[4:7], a[164:167], v[112:115], a[4:7]
  ds_read_b128 a[140:143], v131 offset:49152
  v_exp_f32 v158, v86
  v_mfma_f32_16x16x32_bf16 a[36:39], a[164:167], v[116:119], a[36:39]
  v_exp_f32 v159, v87
  v_mfma_f32_16x16x32_bf16 a[8:11], a[168:171], v[112:115], a[8:11]
  ds_read_b128 a[144:147], v128 offset:53248
  v_cvt_pk_bf16_f32 v121, v154, v155
  v_mfma_f32_16x16x32_bf16 a[40:43], a[168:171], v[116:119], a[40:43]
  buffer_load_dwordx4 v141, s[52:55], s78 offen offset:1024 nt lds
  v_mfma_f32_16x16x32_bf16 a[12:15], a[172:175], v[112:115], a[12:15]
  ds_read_b128 a[148:151], v129 offset:53248
  v_cvt_pk_bf16_f32 v122, v156, v157
  v_mfma_f32_16x16x32_bf16 a[44:47], a[172:175], v[116:119], a[44:47]
  v_exp_f32 v152, v88
  v_mfma_f32_16x16x32_bf16 a[16:19], a[176:179], v[112:115], a[16:19]
  ds_read_b128 a[152:155], v130 offset:53248
  v_cvt_pk_bf16_f32 v123, v158, v159
  v_mfma_f32_16x16x32_bf16 a[48:51], a[176:179], v[116:119], a[48:51]
  buffer_load_dwordx4 v142, s[52:55], s78 offen offset:2048 nt lds
  v_mfma_f32_16x16x32_bf16 a[20:23], a[180:183], v[112:115], a[20:23]
  ds_read_b128 a[156:159], v131 offset:53248
  v_or3_b32 v172, v120, v121, v122
  v_mfma_f32_16x16x32_bf16 a[52:55], a[180:183], v[116:119], a[52:55]
  v_exp_f32 v153, v89
  v_mfma_f32_16x16x32_bf16 a[24:27], a[184:187], v[112:115], a[24:27]
  v_exp_f32 v154, v90
  v_mfma_f32_16x16x32_bf16 a[56:59], a[184:187], v[116:119], a[56:59]
  buffer_load_dwordx4 v143, s[52:55], s78 offen offset:3072 nt lds
  v_mfma_f32_16x16x32_bf16 a[28:31], a[188:191], v[112:115], a[28:31]
  v_exp_f32 v155, v91
  v_mfma_f32_16x16x32_bf16 a[60:63], a[188:191], v[116:119], a[60:63]
  v_exp_f32 v156, v92
  v_mfma_f32_16x16x32_bf16 v[224:227], a[192:195], v[112:115], v[224:227]
  v_cvt_pk_bf16_f32 v124, v152, v153
  s_add_u32 s76, s76, 1
  v_mfma_f32_16x16x32_bf16 v[228:231], a[192:195], v[116:119], v[228:231]
  s_cmp_ge_u32 s76, s77
  s_cbranch_scc1 L_drain
  s_waitcnt lgkmcnt(0)
  v_mfma_f32_16x16x32_bf16 v[64:67], a[128:131], v[0:3], v[96:99]
  v_exp_f32 v157, v93
  v_mfma_f32_16x16x32_bf16 v[64:67], a[132:135], v[4:7], v[64:67]
  v_cvt_pk_bf16_f32 v125, v154, v155
  v_or3_b32 v172, v172, v123, v124
  v_mfma_f32_16x16x32_bf16 v[64:67], a[136:139], v[8:11], v[64:67]
  v_exp_f32 v158, v94
  v_mfma_f32_16x16x32_bf16 v[64:67], a[140:143], v[12:15], v[64:67]
  v_exp_f32 v159, v95
  v_mfma_f32_16x16x32_bf16 v[68:71], a[144:147], v[0:3], v[96:99]
  v_cvt_pk_bf16_f32 v126, v156, v157
  v_cvt_pk_bf16_f32 v127, v158, v159
  v_mfma_f32_16x16x32_bf16 v[68:71], a[148:151], v[4:7], v[68:71]
  v_or3_b32 v172, v172, v125, v126
  v_bitop3_b32 v172, v172, v127, s80 bitop3:0xa8
  v_cmp_ne_u32 vcc, 0, v172
  v_mfma_f32_16x16x32_bf16 v[68:71], a[152:155], v[8:11], v[68:71]
  v_exp_f32 v162, v64
  v_mfma_f32_16x16x32_bf16 v[68:71], a[156:159], v[12:15], v[68:71]
  v_exp_f32 v163, v65
  v_mfma_f32_16x16x32_bf16 v[72:75], a[128:131], v[16:19], v[100:103]
  s_cbranch_vccnz L_stub_b3
L_back_b3:
  v_mfma_f32_16x16x32_bf16 v[72:75], a[132:135], v[20:23], v[72:75]
  v_exp_f32 v164, v66
  v_mfma_f32_16x16x32_bf16 v[72:75], a[136:139], v[24:27], v[72:75]
  v_cvt_pk_bf16_f32 v112, v162, v163
  v_mfma_f32_16x16x32_bf16 v[72:75], a[140:143], v[28:31], v[72:75]
  v_exp_f32 v165, v67
  v_mfma_f32_16x16x32_bf16 v[76:79], a[144:147], v[16:19], v[100:103]
  v_exp_f32 v166, v68
  v_mfma_f32_16x16x32_bf16 v[76:79], a[148:151], v[20:23], v[76:79]
  v_cvt_pk_bf16_f32 v113, v164, v165
  v_mfma_f32_16x16x32_bf16 v[76:79], a[152:155], v[24:27], v[76:79]
  v_exp_f32 v167, v69
  v_mfma_f32_16x16x32_bf16 v[76:79], a[156:159], v[28:31], v[76:79]
  v_exp_f32 v168, v70
  v_mfma_f32_16x16x32_bf16 a[64:67], a[160:163], v[120:123], a[64:67]
  v_cvt_pk_bf16_f32 v114, v166, v167
  v_mfma_f32_16x16x32_bf16 a[96:99], a[160:163], v[124:127], a[96:99]
  v_exp_f32 v169, v71
  v_mfma_f32_16x16x32_bf16 a[68:71], a[164:167], v[120:123], a[68:71]
  ds_read_b64_tr_b16 a[160:161], v132 offset:57344
  ds_read_b64_tr_b16 a[162:163], v132 offset:61440
  v_mfma_f32_16x16x32_bf16 a[100:103], a[164:167], v[124:127], a[100:103]
  v_cvt_pk_bf16_f32 v115, v168, v169
  v_mfma_f32_16x16x32_bf16 a[72:75], a[168:171], v[120:123], a[72:75]
  ds_read_b64_tr_b16 a[164:165], v133 offset:57344
  ds_read_b64_tr_b16 a[166:167], v133 offset:61440
  v_mfma_f32_16x16x32_bf16 a[104:107], a[168:171], v[124:127], a[104:107]
  v_exp_f32 v162, v72
  v_mfma_f32_16x16x32_bf16 a[76:79], a[172:175], v[120:123], a[76:79]
  ds_read_b64_tr_b16 a[168:169], v134 offset:57344
  ds_read_b64_tr_b16 a[170:171], v134 offset:61440
  v_mfma_f32_16x16x32_bf16 a[108:111], a[172:175], v[124:127], a[108:111]
  v_exp_f32 v163, v73
  v_mfma_f32_16x16x32_bf16 a[80:83], a[176:179], v[120:123], a[80:83]
  ds_read_b64_tr_b16 a[172:173], v135 offset:57344
  ds_read_b64_tr_b16 a[174:175], v135 offset:61440
  v_mfma_f32_16x16x32_bf16 a[112:115], a[176:179], v[124:127], a[112:115]
  v_exp_f32 v164, v74
  v_mfma_f32_16x16x32_bf16 a[84:87], a[180:183], v[120:123], a[84:87]
  ds_read_b64_tr_b16 a[176:177], v136 offset:57344
  ds_read_b64_tr_b16 a[178:179], v136 offset:61440
  v_mfma_f32_16x16x32_bf16 a[116:119], a[180:183], v[124:127], a[116:119]
  v_exp_f32 v165, v75
  v_mfma_f32_16x16x32_bf16 a[88:91], a[184:187], v[120:123], a[88:91]
  ds_read_b64_tr_b16 a[180:181], v137 offset:57344
  ds_read_b64_tr_b16 a[182:183], v137 offset:61440
  v_mfma_f32_16x16x32_bf16 a[120:123], a[184:187], v[124:127], a[120:123]
  v_or3_b32 v170, v112, v113, v114
  v_cvt_pk_bf16_f32 v116, v162, v163
  v_mfma_f32_16x16x32_bf16 a[92:95], a[188:191], v[120:123], a[92:95]
  ds_read_b64_tr_b16 a[184:185], v138 offset:57344
  ds_read_b64_tr_b16 a[186:187], v138 offset:61440
  v_mfma_f32_16x16x32_bf16 a[124:127], a[188:191], v[124:127], a[124:127]
  v_exp_f32 v166, v76
  v_mfma_f32_16x16x32_bf16 v[232:235], a[192:195], v[120:123], v[232:235]
  ds_read_b64_tr_b16 a[188:189], v139 offset:57344
  ds_read_b64_tr_b16 a[190:191], v139 offset:61440
  v_mfma_f32_16x16x32_bf16 v[236:239], a[192:195], v[124:127], v[236:239]
  v_exp_f32 v167, v77
  v_mfma_f32_16x16x32_bf16 v[80:83], a[128:131], v[32:35], v[104:107]
  v_cvt_pk_bf16_f32 v117, v164, v165
  v_or3_b32 v170, v170, v115, v116
  v_mfma_f32_16x16x32_bf16 v[80:83], a[132:135], v[36:39], v[80:83]
  v_exp_f32 v168, v78
  v_mfma_f32_16x16x32_bf16 v[80:83], a[136:139], v[40:43], v[80:83]
  v_exp_f32 v169, v79
  v_mfma_f32_16x16x32_bf16 v[80:83], a[140:143], v[44:47], v[80:83]
  v_cvt_pk_bf16_f32 v118, v166, v167
  v_cvt_pk_bf16_f32 v119, v168, v169
  v_mfma_f32_16x16x32_bf16 v[84:87], a[144:147], v[32:35], v[104:107]
  v_readlane_b32 s78, v144, s76
  v_or3_b32 v170, v170, v117, v118
  v_mfma_f32_16x16x32_bf16 v[84:87], a[148:151], v[36:39], v[84:87]
  v_bitop3_b32 v170, v170, v119, s80 bitop3:0xa8
  v_cmp_ne_u32 vcc, 0, v170
  v_mfma_f32_16x16x32_bf16 v[84:87], a[152:155], v[40:43], v[84:87]
  s_waitcnt vmcnt(8) lgkmcnt(0)
  s_barrier
  v_mfma_f32_16x16x32_bf16 v[84:87], a[156:159], v[44:47], v[84:87]
  v_exp_f32 v152, v80
  v_mfma_f32_16x16x32_bf16 v[88:91], a[128:131], v[48:51], v[108:111]
  s_add_u32 m0, s79, 49152
  s_cbranch_vccnz L_stub_a3
L_back_a3:
  v_mfma_f32_16x16x32_bf16 v[88:91], a[132:135], v[52:55], v[88:91]
  v_exp_f32 v153, v81
  v_mfma_f32_16x16x32_bf16 v[88:91], a[136:139], v[56:59], v[88:91]
  v_exp_f32 v154, v82
  v_mfma_f32_16x16x32_bf16 v[88:91], a[140:143], v[60:63], v[88:91]
  v_exp_f32 v155, v83
  v_mfma_f32_16x16x32_bf16 v[92:95], a[144:147], v[48:51], v[108:111]
  ds_read_b128 a[128:131], v128 offset:0
  v_mfma_f32_16x16x32_bf16 v[92:95], a[148:151], v[52:55], v[92:95]
  v_exp_f32 v156, v84
  v_mfma_f32_16x16x32_bf16 v[92:95], a[152:155], v[56:59], v[92:95]
  ds_read_b128 a[132:135], v129 offset:0
  v_mfma_f32_16x16x32_bf16 v[92:95], a[156:159], v[60:63], v[92:95]
  v_exp_f32 v157, v85
  v_mfma_f32_16x16x32_bf16 a[0:3], a[160:163], v[112:115], a[0:3]
  ds_read_b128 a[136:139], v130 offset:0
  v_cvt_pk_bf16_f32 v120, v152, v153
  v_mfma_f32_16x16x32_bf16 a[32:35], a[160:163], v[116:119], a[32:35]
  buffer_load_dwordx4 v140, s[52:55], s78 offen offset:0 nt lds
  v_mfma_f32_16x16x32_bf16 a[4:7], a[164:167], v[112:115], a[4:7]
  ds_read_b128 a[140:143], v131 offset:0
  v_exp_f32 v158, v86
  v_mfma_f32_16x16x32_bf16 a[36:39], a[164:167], v[116:119], a[36:39]
  v_exp_f32 v159, v87
  v_mfma_f32_16x16x32_bf16 a[8:11], a[168:171], v[112:115], a[8:11]
  ds_read_b128 a[144:147], v128 offset:4096
  v_cvt_pk_bf16_f32 v121, v154, v155
  v_mfma_f32_16x16x32_bf16 a[40:43], a[168:171], v[116:119], a[40:43]
  buffer_load_dwordx4 v141, s[52:55], s78 offen offset:1024 nt lds
  v_mfma_f32_16x16x32_bf16 a[12:15], a[172:175], v[112:115], a[12:15]
  ds_read_b128 a[148:151], v129 offset:4096
  v_cvt_pk_bf16_f32 v122, v156, v157
  v_mfma_f32_16x16x32_bf16 a[44:47], a[172:175], v[116:119], a[44:47]
  v_exp_f32 v152, v88
  v_mfma_f32_16x16x32_bf16 a[16:19], a[176:179], v[112:115], a[16:19]
  ds_read_b128 a[152:155], v130 offset:4096
  v_cvt_pk_bf16_f32 v123, v158, v159
  v_mfma_f32_16x16x32_bf16 a[48:51], a[176:179], v[116:119], a[48:51]
  buffer_load_dwordx4 v142, s[52:55], s78 offen offset:2048 nt lds
  v_mfma_f32_16x16x32_bf16 a[20:23], a[180:183], v[112:115], a[20:23]
  ds_read_b128 a[156:159], v131 offset:4096
  v_or3_b32 v172, v120, v121, v122
  v_mfma_f32_16x16x32_bf16 a[52:55], a[180:183], v[116:119], a[52:55]
  v_exp_f32 v153, v89
  v_mfma_f32_16x16x32_bf16 a[24:27], a[184:187], v[112:115], a[24:27]
  v_exp_f32 v154, v90
  v_mfma_f32_16x16x32_bf16 a[56:59], a[184:187], v[116:119], a[56:59]
  buffer_load_dwordx4 v143, s[52:55], s78 offen offset:3072 nt lds
  v_mfma_f32_16x16x32_bf16 a[28:31], a[188:191], v[112:115], a[28:31]
  v_exp_f32 v155, v91
  v_mfma_f32_16x16x32_bf16 a[60:63], a[188:191], v[116:119], a[60:63]
  v_exp_f32 v156, v92
  v_mfma_f32_16x16x32_bf16 v[224:227], a[192:195], v[112:115], v[224:227]
  v_cvt_pk_bf16_f32 v124, v152, v153
  s_add_u32 s76, s76, 1
  v_mfma_f32_16x16x32_bf16 v[228:231], a[192:195], v[116:119], v[228:231]
  s_cmp_ge_u32 s76, s77
  s_cbranch_scc1 L_drain
  s_waitcnt lgkmcnt(0)
  v_mfma_f32_16x16x32_bf16 v[64:67], a[128:131], v[0:3], v[96:99]
  v_exp_f32 v157, v93
  v_mfma_f32_16x16x32_bf16 v[64:67], a[132:135], v[4:7], v[64:67]
  v_cvt_pk_bf16_f32 v125, v154, v155
  v_or3_b32 v172, v172, v123, v124
  v_mfma_f32_16x16x32_bf16 v[64:67], a[136:139], v[8:11], v[64:67]
  v_exp_f32 v158, v94
  v_mfma_f32_16x16x32_bf16 v[64:67], a[140:143], v[12:15], v[64:67]
  v_exp_f32 v159, v95
  v_mfma_f32_16x16x32_bf16 v[68:71], a[144:147], v[0:3], v[96:99]
  v_cvt_pk_bf16_f32 v126, v156, v157
  v_cvt_pk_bf16_f32 v127, v158, v159
  v_mfma_f32_16x16x32_bf16 v[68:71], a[148:151], v[4:7], v[68:71]
  v_or3_b32 v172, v172, v125, v126
  v_bitop3_b32 v172, v172, v127, s80 bitop3:0xa8
  v_cmp_ne_u32 vcc, 0, v172
  v_mfma_f32_16x16x32_bf16 v[68:71], a[152:155], v[8:11], v[68:71]
  v_exp_f32 v162, v64
  v_mfma_f32_16x16x32_bf16 v[68:71], a[156:159], v[12:15], v[68:71]
  v_exp_f32 v163, v65
  v_mfma_f32_16x16x32_bf16 v[72:75], a[128:131], v[16:19], v[100:103]
  s_cbranch_vccnz L_stub_b0
L_back_b0:
  v_mfma_f32_16x16x32_bf16 v[72:75], a[132:135], v[20:23], v[72:75]
  v_exp_f32 v164, v66
  v_mfma_f32_16x16x32_bf16 v[72:75], a[136:139], v[24:27], v[72:75]
  v_cvt_pk_bf16_f32 v112, v162, v163
  v_mfma_f32_16x16x32_bf16 v[72:75], a[140:143], v[28:31], v[72:75]
  v_exp_f32 v165, v67
  v_mfma_f32_16x16x32_bf16 v[76:79], a[144:147], v[16:19], v[100:103]
  v_exp_f32 v166, v68
  v_mfma_f32_16x16x32_bf16 v[76:79], a[148:151], v[20:23], v[76:79]
  v_cvt_pk_bf16_f32 v113, v164, v165
  v_mfma_f32_16x16x32_bf16 v[76:79], a[152:155], v[24:27], v[76:79]
  v_exp_f32 v167, v69
  v_mfma_f32_16x16x32_bf16 v[76:79], a[156:159], v[28:31], v[76:79]
  v_exp_f32 v168, v70
  v_mfma_f32_16x16x32_bf16 a[64:67], a[160:163], v[120:123], a[64:67]
  v_cvt_pk_bf16_f32 v114, v166, v167
  v_mfma_f32_16x16x32_bf16 a[96:99], a[160:163], v[124:127], a[96:99]
  v_exp_f32 v169, v71
  v_mfma_f32_16x16x32_bf16 a[68:71], a[164:167], v[120:123], a[68:71]
  ds_read_b64_tr_b16 a[160:161], v132 offset:8192
  ds_read_b64_tr_b16 a[162:163], v132 offset:12288
  v_mfma_f32_16x16x32_bf16 a[100:103], a[164:167], v[124:127], a[100:103]
  v_cvt_pk_bf16_f32 v115, v168, v169
  v_mfma_f32_16x16x32_bf16 a[72:75], a[168:171], v[120:123], a[72:75]
  ds_read_b64_tr_b16 a[164:165], v133 offset:8192
  ds_read_b64_tr_b16 a[166:167], v133 offset:12288
  v_mfma_f32_16x16x32_bf16 a[104:107], a[168:171], v[124:127], a[104:107]
  v_exp_f32 v162, v72
  v_mfma_f32_16x16x32_bf16 a[76:79], a[172:175], v[120:123], a[76:79]
  ds_read_b64_tr_b16 a[168:169], v134 offset:8192
  ds_read_b64_tr_b16 a[170:171], v134 offset:12288
  v_mfma_f32_16x16x32_bf16 a[108:111], a[172:175], v[124:127], a[108:111]
  v_exp_f32 v163, v73
  v_mfma_f32_16x16x32_bf16 a[80:83], a[176:179], v[120:123], a[80:83]
  ds_read_b64_tr_b16 a[172:173], v135 offset:8192
  ds_read_b64_tr_b16 a[174:175], v135 offset:12288
  v_mfma_f32_16x16x32_bf16 a[112:115], a[176:179], v[124:127], a[112:115]
  v_exp_f32 v164, v74
  v_mfma_f32_16x16x32_bf16 a[84:87], a[180:183], v[120:123], a[84:87]
  ds_read_b64_tr_b16 a[176:177], v136 offset:8192
  ds_read_b64_tr_b16 a[178:179], v136 offset:12288
  v_mfma_f32_16x16x32_bf16 a[116:119], a[180:183], v[124:127], a[116:119]
  v_exp_f32 v165, v75
  v_mfma_f32_16x16x32_bf16 a[88:91], a[184:187], v[120:123], a[88:91]
  ds_read_b64_tr_b16 a[180:181], v137 offset:8192
  ds_read_b64_tr_b16 a[182:183], v137 offset:12288
  v_mfma_f32_16x16x32_bf16 a[120:123], a[184:187], v[124:127], a[120:123]
  v_or3_b32 v170, v112, v113, v114
  v_cvt_pk_bf16_f32 v116, v162, v163
  v_mfma_f32_16x16x32_bf16 a[92:95], a[188:191], v[120:123], a[92:95]
  ds_read_b64_tr_b16 a[184:185], v138 offset:8192
  ds_read_b64_tr_b16 a[186:187], v138 offset:12288
  v_mfma_f32_16x16x32_bf16 a[124:127], a[188:191], v[124:127], a[124:127]
  v_exp_f32 v166, v76
  v_mfma_f32_16x16x32_bf16 v[232:235], a[192:195], v[120:123], v[232:235]
  ds_read_b64_tr_b16 a[188:189], v139 offset:8192
  ds_read_b64_tr_b16 a[190:191], v139 offset:12288
  v_mfma_f32_16x16x32_bf16 v[236:239], a[192:195], v[124:127], v[236:239]
  v_exp_f32 v167, v77
  v_mfma_f32_16x16x32_bf16 v[80:83], a[128:131], v[32:35], v[104:107]
  v_cvt_pk_bf16_f32 v117, v164, v165
  v_or3_b32 v170, v170, v115, v116
  v_mfma_f32_16x16x32_bf16 v[80:83], a[132:135], v[36:39], v[80:83]
  v_exp_f32 v168, v78
  v_mfma_f32_16x16x32_bf16 v[80:83], a[136:139], v[40:43], v[80:83]
  v_exp_f32 v169, v79
  v_mfma_f32_16x16x32_bf16 v[80:83], a[140:143], v[44:47], v[80:83]
  v_cvt_pk_bf16_f32 v118, v166, v167
  v_cvt_pk_bf16_f32 v119, v168, v169
  v_mfma_f32_16x16x32_bf16 v[84:87], a[144:147], v[32:35], v[104:107]
  v_readlane_b32 s78, v144, s76
  v_or3_b32 v170, v170, v117, v118
  v_mfma_f32_16x16x32_bf16 v[84:87], a[148:151], v[36:39], v[84:87]
  v_bitop3_b32 v170, v170, v119, s80 bitop3:0xa8
  v_cmp_ne_u32 vcc, 0, v170
  v_mfma_f32_16x16x32_bf16 v[84:87], a[152:155], v[40:43], v[84:87]
  s_waitcnt vmcnt(8) lgkmcnt(0)
  s_barrier
  v_mfma_f32_16x16x32_bf16 v[84:87], a[156:159], v[44:47], v[84:87]
  v_exp_f32 v152, v80
  v_mfma_f32_16x16x32_bf16 v[88:91], a[128:131], v[48:51], v[108:111]
  s_add_u32 m0, s79, 0
  s_cbranch_vccnz L_stub_a0
L_back_a0:
  v_mfma_f32_16x16x32_bf16 v[88:91], a[132:135], v[52:55], v[88:91]
  v_exp_f32 v153, v81
  v_mfma_f32_16x16x32_bf16 v[88:91], a[136:139], v[56:59], v[88:91]
  v_exp_f32 v154, v82
  v_mfma_f32_16x16x32_bf16 v[88:91], a[140:143], v[60:63], v[88:91]
  v_exp_f32 v155, v83
  v_mfma_f32_16x16x32_bf16 v[92:95], a[144:147], v[48:51], v[108:111]
  ds_read_b128 a[128:131], v128 offset:16384
  v_mfma_f32_16x16x32_bf16 v[92:95], a[148:151], v[52:55], v[92:95]
  v_exp_f32 v156, v84
  v_mfma_f32_16x16x32_bf16 v[92:95], a[152:155], v[56:59], v[92:95]
  ds_read_b128 a[132:135], v129 offset:16384
  v_mfma_f32_16x16x32_bf16 v[92:95], a[156:159], v[60:63], v[92:95]
  v_exp_f32 v157, v85
  v_mfma_f32_16x16x32_bf16 a[0:3], a[160:163], v[112:115], a[0:3]
  ds_read_b128 a[136:139], v130 offset:16384
  v_cvt_pk_bf16_f32 v120, v152, v153
  v_mfma_f32_16x16x32_bf16 a[32:35], a[160:163], v[116:119], a[32:35]
  buffer_load_dwordx4 v140, s[52:55], s78 offen offset:0 nt lds
  v_mfma_f32_16x16x32_bf16 a[4:7], a[164:167], v[112:115], a[4:7]
  ds_read_b128 a[140:143], v131 offset:16384
  v_exp_f32 v158, v86
  v_mfma_f32_16x16x32_bf16 a[36:39], a[164:167], v[116:119], a[36:39]
  v_exp_f32 v159, v87
  v_mfma_f32_16x16x32_bf16 a[8:11], a[168:171], v[112:115], a[8:11]
  ds_read_b128 a[144:147], v128 offset:20480
  v_cvt_pk_bf16_f32 v121, v154, v155
  v_mfma_f32_16x16x32_bf16 a[40:43], a[168:171], v[116:119], a[40:43]
  buffer_load_dwordx4 v141, s[52:55], s78 offen offset:1024 nt lds
  v_mfma_f32_16x16x32_bf16 a[12:15], a[172:175], v[112:115], a[12:15]
  ds_read_b128 a[148:151], v129 offset:20480
  v_cvt_pk_bf16_f32 v122, v156, v157
  v_mfma_f32_16x16x32_bf16 a[44:47], a[172:175], v[116:119], a[44:47]
  v_exp_f32 v152, v88
  v_mfma_f32_16x16x32_bf16 a[16:19], a[176:179], v[112:115], a[16:19]
  ds_read_b128 a[152:155], v130 offset:20480
  v_cvt_pk_bf16_f32 v123, v158, v159
  v_mfma_f32_16x16x32_bf16 a[48:51], a[176:179], v[116:119], a[48:51]
  buffer_load_dwordx4 v142, s[52:55], s78 offen offset:2048 nt lds
  v_mfma_f32_16x16x32_bf16 a[20:23], a[180:183], v[112:115], a[20:23]
  ds_read_b128 a[156:159], v131 offset:20480
  v_or3_b32 v172, v120, v121, v122
  v_mfma_f32_16x16x32_bf16 a[52:55], a[180:183], v[116:119], a[52:55]
  v_exp_f32 v153, v89
  v_mfma_f32_16x16x32_bf16 a[24:27], a[184:187], v[112:115], a[24:27]
  v_exp_f32 v154, v90
  v_mfma_f32_16x16x32_bf16 a[56:59], a[184:187], v[116:119], a[56:59]
  buffer_load_dwordx4 v143, s[52:55], s78 offen offset:3072 nt lds
  v_mfma_f32_16x16x32_bf16 a[28:31], a[188:191], v[112:115], a[28:31]
  v_exp_f32 v155, v91
  v_mfma_f32_16x16x32_bf16 a[60:63], a[188:191], v[116:119], a[60:63]
  v_exp_f32 v156, v92
  v_mfma_f32_16x16x32_bf16 v[224:227], a[192:195], v[112:115], v[224:227]
  v_cvt_pk_bf16_f32 v124, v152, v153
  s_add_u32 s76, s76, 1
  v_mfma_f32_16x16x32_bf16 v[228:231], a[192:195], v[116:119], v[228:231]
  s_cmp_ge_u32 s76, s77
  s_cbranch_scc0 L_loop
L_drain:
  s_nop 0
  v_exp_f32 v157, v93
  v_cvt_pk_bf16_f32 v125, v154, v155
  v_or3_b32 v172, v172, v123, v124
  v_exp_f32 v158, v94
  v_exp_f32 v159, v95
  v_cvt_pk_bf16_f32 v126, v156, v157
  v_cvt_pk_bf16_f32 v127, v158, v159
  v_or3_b32 v172, v172, v125, v126
  v_bitop3_b32 v172, v172, v127, s80 bitop3:0xa8
  v_cmp_ne_u32 vcc, 0, v172
  s_cbranch_vccnz L_stub_bd
L_back_bd:
  s_lshl_b32 s38, s64, 6
  s_add_u32 s38, s38, s101
  s_lshl_b32 s84, s81, 10
  s_lshl_b32 s83, s38, 16
  s_lshl_b32 s85, s67, 10
  s_add_u32 s83, s83, s85
  s_lshl_b32 s85, s20, 1
  s_xor_b32 s86, s95, 1
  s_add_u32 s86, s86, s85
  s_add_u32 s85, s85, s95
  s_lshl_b32 s89, s84, 3
  s_mul_i32 s86, s86, s89
  s_mul_i32 s85, s85, s89
  s_add_u32 s89, s83, s86
  s_add_u32 s83, s83, s85
  s_lshl_b32 s87, s38, 11
  s_lshl_b32 s85, s20, 1
  s_mul_i32 s85, s85, s81
  s_add_u32 s85, s85, s67
  s_lshl_b32 s85, s85, 8
  s_add_u32 s87, s87, s85
  s_add_u32 s87, s87, 16777216
  s_lshl_b32 s88, s81, 8
  v_lshlrev_b32 v194, 4, v161
  v_mfma_f32_16x16x32_bf16 a[64:67], a[160:163], v[120:123], a[64:67]
  v_accvgpr_read_b32 v64, a0
  v_accvgpr_read_b32 v65, a1
  v_accvgpr_read_b32 v66, a2
  v_accvgpr_read_b32 v67, a3
  v_accvgpr_read_b32 v68, a4
  v_accvgpr_read_b32 v69, a5
  v_mfma_f32_16x16x32_bf16 a[96:99], a[160:163], v[124:127], a[96:99]
  v_accvgpr_read_b32 v70, a6
  v_accvgpr_read_b32 v71, a7
  v_cvt_pk_bf16_f32 v96, v64, v65
  v_cvt_pk_bf16_f32 v97, v66, v67
  v_cvt_pk_bf16_f32 v98, v68, v69
  v_cvt_pk_bf16_f32 v99, v70, v71
  v_mfma_f32_16x16x32_bf16 a[68:71], a[164:167], v[120:123], a[68:71]
  buffer_store_dwordx4 v[96:99], v194, s[60:63], s83 offen sc1
  s_add_u32 s83, s83, s84
  v_accvgpr_read_b32 v72, a8
  v_accvgpr_read_b32 v73, a9
  v_accvgpr_read_b32 v74, a10
  v_accvgpr_read_b32 v75, a11
  v_mfma_f32_16x16x32_bf16 a[100:103], a[164:167], v[124:127], a[100:103]
  v_accvgpr_read_b32 v76, a12
  v_accvgpr_read_b32 v77, a13
  v_accvgpr_read_b32 v78, a14
  v_accvgpr_read_b32 v79, a15
  v_cvt_pk_bf16_f32 v100, v72, v73
  v_cvt_pk_bf16_f32 v101, v74, v75
  v_mfma_f32_16x16x32_bf16 a[72:75], a[168:171], v[120:123], a[72:75]
  v_cvt_pk_bf16_f32 v102, v76, v77
  v_cvt_pk_bf16_f32 v103, v78, v79
  buffer_store_dwordx4 v[100:103], v194, s[60:63], s83 offen sc1
  s_add_u32 s83, s83, s84
  v_accvgpr_read_b32 v64, a16
  v_accvgpr_read_b32 v65, a17
  v_accvgpr_read_b32 v66, a18
  v_mfma_f32_16x16x32_bf16 a[104:107], a[168:171], v[124:127], a[104:107]
  v_accvgpr_read_b32 v67, a19
  v_accvgpr_read_b32 v68, a20
  v_accvgpr_read_b32 v69, a21
  v_accvgpr_read_b32 v70, a22
  v_accvgpr_read_b32 v71, a23
  v_cvt_pk_bf16_f32 v96, v64, v65
  v_mfma_f32_16x16x32_bf16 a[76:79], a[172:175], v[120:123], a[76:79]
  v_cvt_pk_bf16_f32 v97, v66, v67
  v_cvt_pk_bf16_f32 v98, v68, v69
  v_cvt_pk_bf16_f32 v99, v70, v71
  buffer_store_dwordx4 v[96:99], v194, s[60:63], s83 offen sc1
  s_add_u32 s83, s83, s84
  v_accvgpr_read_b32 v72, a24
  v_mfma_f32_16x16x32_bf16 a[108:111], a[172:175], v[124:127], a[108:111]
  v_accvgpr_read_b32 v73, a25
  v_accvgpr_read_b32 v74, a26
  v_accvgpr_read_b32 v75, a27
  v_accvgpr_read_b32 v76, a28
  v_accvgpr_read_b32 v77, a29
  v_accvgpr_read_b32 v78, a30
  v_mfma_f32_16x16x32_bf16 a[80:83], a[176:179], v[120:123], a[80:83]
  v_accvgpr_read_b32 v79, a31
  v_cvt_pk_bf16_f32 v100, v72, v73
  v_cvt_pk_bf16_f32 v101, v74, v75
  v_cvt_pk_bf16_f32 v102, v76, v77
  v_cvt_pk_bf16_f32 v103, v78, v79
  buffer_store_dwordx4 v[100:103], v194, s[60:63], s83 offen sc1
  s_add_u32 s83, s83, s84
  v_mfma_f32_16x16x32_bf16 a[112:115], a[176:179], v[124:127], a[112:115]
  v_accvgpr_read_b32 v64, a32
  v_accvgpr_read_b32 v65, a33
  v_accvgpr_read_b32 v66, a34
  v_accvgpr_read_b32 v67, a35
  v_accvgpr_read_b32 v68, a36
  v_accvgpr_read_b32 v69, a37
  v_mfma_f32_16x16x32_bf16 a[84:87], a[180:183], v[120:123], a[84:87]
  v_accvgpr_read_b32 v70, a38
  v_accvgpr_read_b32 v71, a39
  v_cvt_pk_bf16_f32 v96, v64, v65
  v_cvt_pk_bf16_f32 v97, v66, v67
  v_cvt_pk_bf16_f32 v98, v68, v69
  v_cvt_pk_bf16_f32 v99, v70, v71
  v_mfma_f32_16x16x32_bf16 a[116:119], a[180:183], v[124:127], a[116:119]
  buffer_store_dwordx4 v[96:99], v194, s[60:63], s83 offen sc1
  s_add_u32 s83, s83, s84
  v_accvgpr_read_b32 v72, a40
  v_accvgpr_read_b32 v73, a41
  v_accvgpr_read_b32 v74, a42
  v_accvgpr_read_b32 v75, a43
  v_mfma_f32_16x16x32_bf16 a[88:91], a[184:187], v[120:123], a[88:91]
  v_accvgpr_read_b32 v76, a44
  v_accvgpr_read_b32 v77, a45
  v_accvgpr_read_b32 v78, a46
  v_accvgpr_read_b32 v79, a47
  v_cvt_pk_bf16_f32 v100, v72, v73
  v_cvt_pk_bf16_f32 v101, v74, v75
  v_mfma_f32_16x16x32_bf16 a[120:123], a[184:187], v[124:127], a[120:123]
  v_cvt_pk_bf16_f32 v102, v76, v77
  v_cvt_pk_bf16_f32 v103, v78, v79
  buffer_store_dwordx4 v[100:103], v194, s[60:63], s83 offen sc1
  s_add_u32 s83, s83, s84
  v_accvgpr_read_b32 v64, a48
  v_accvgpr_read_b32 v65, a49
  v_accvgpr_read_b32 v66, a50
  v_mfma_f32_16x16x32_bf16 a[92:95], a[188:191], v[120:123], a[92:95]
  v_accvgpr_read_b32 v67, a51
  v_accvgpr_read_b32 v68, a52
  v_accvgpr_read_b32 v69, a53
  v_accvgpr_read_b32 v70, a54
  v_accvgpr_read_b32 v71, a55
  v_cvt_pk_bf16_f32 v96, v64, v65
  v_mfma_f32_16x16x32_bf16 a[124:127], a[188:191], v[124:127], a[124:127]
  v_cvt_pk_bf16_f32 v97, v66, v67
  v_cvt_pk_bf16_f32 v98, v68, v69
  v_cvt_pk_bf16_f32 v99, v70, v71
  buffer_store_dwordx4 v[96:99], v194, s[60:63], s83 offen sc1
  s_add_u32 s83, s83, s84
  v_accvgpr_read_b32 v72, a56
  v_mfma_f32_16x16x32_bf16 v[232:235], a[192:195], v[120:123], v[232:235]
  v_accvgpr_read_b32 v73, a57
  v_accvgpr_read_b32 v74, a58
  v_accvgpr_read_b32 v75, a59
  v_accvgpr_read_b32 v76, a60
  v_accvgpr_read_b32 v77, a61
  v_accvgpr_read_b32 v78, a62
  v_mfma_f32_16x16x32_bf16 v[236:239], a[192:195], v[124:127], v[236:239]
  v_accvgpr_read_b32 v79, a63
  v_cvt_pk_bf16_f32 v100, v72, v73
  v_cvt_pk_bf16_f32 v101, v74, v75
  v_cvt_pk_bf16_f32 v102, v76, v77
  v_cvt_pk_bf16_f32 v103, v78, v79
  buffer_store_dwordx4 v[100:103], v194, s[60:63], s83 offen sc1
  s_add_u32 s83, s83, s84
  s_nop 7
  v_lshrrev_b32 v195, 4, v161
  v_mov_b32 v162, v178
  v_mov_b32 v163, v224
  v_cmp_eq_u32 vcc, 1, v195
  s_nop 1
  v_cndmask_b32 v162, v162, v179, vcc
  v_cndmask_b32 v163, v163, v228, vcc
  v_cmp_eq_u32 vcc, 2, v195
  s_nop 1
  v_cndmask_b32 v162, v162, v180, vcc
  v_cndmask_b32 v163, v163, v232, vcc
  v_cmp_eq_u32 vcc, 3, v195
  s_nop 1
  v_cndmask_b32 v162, v162, v181, vcc
  v_cndmask_b32 v163, v163, v236, vcc
  v_cmp_gt_u32 vcc, 32, v161
  v_and_b32 v196, 31, v161
  v_lshlrev_b32 v196, 3, v196
  s_mul_i32 s85, s88, s95
  s_sub_u32 s86, s88, s85
  v_add_u32 v197, s86, v196
  v_add_u32 v196, s85, v196
  v_cndmask_b32 v196, v197, v196, vcc
  buffer_store_dwordx2 v[162:163], v196, s[60:63], s87 offen sc1
  s_mov_b32 s83, s89
  v_accvgpr_read_b32 v64, a64
  v_accvgpr_read_b32 v65, a65
  v_accvgpr_read_b32 v66, a66
  v_accvgpr_read_b32 v67, a67
  v_accvgpr_read_b32 v68, a68
  v_accvgpr_read_b32 v69, a69
  v_accvgpr_read_b32 v70, a70
  v_accvgpr_read_b32 v71, a71
  v_cvt_pk_bf16_f32 v96, v64, v65
  v_cvt_pk_bf16_f32 v97, v66, v67
  v_cvt_pk_bf16_f32 v98, v68, v69
  v_cvt_pk_bf16_f32 v99, v70, v71
  buffer_store_dwordx4 v[96:99], v194, s[60:63], s83 offen sc1
  s_add_u32 s83, s83, s84
  v_accvgpr_read_b32 v72, a72
  v_accvgpr_read_b32 v73, a73
  v_accvgpr_read_b32 v74, a74
  v_accvgpr_read_b32 v75, a75
  v_accvgpr_read_b32 v76, a76
  v_accvgpr_read_b32 v77, a77
  v_accvgpr_read_b32 v78, a78
  v_accvgpr_read_b32 v79, a79
  v_cvt_pk_bf16_f32 v100, v72, v73
  v_cvt_pk_bf16_f32 v101, v74, v75
  v_cvt_pk_bf16_f32 v102, v76, v77
  v_cvt_pk_bf16_f32 v103, v78, v79
  buffer_store_dwordx4 v[100:103], v194, s[60:63], s83 offen sc1
  s_add_u32 s83, s83, s84
  v_accvgpr_read_b32 v64, a80
  v_accvgpr_read_b32 v65, a81
  v_accvgpr_read_b32 v66, a82
  v_accvgpr_read_b32 v67, a83
  v_accvgpr_read_b32 v68, a84
  v_accvgpr_read_b32 v69, a85
  v_accvgpr_read_b32 v70, a86
  v_accvgpr_read_b32 v71, a87
  v_cvt_pk_bf16_f32 v104, v64, v65
  v_cvt_pk_bf16_f32 v105, v66, v67
  v_cvt_pk_bf16_f32 v106, v68, v69
  v_cvt_pk_bf16_f32 v107, v70, v71
  buffer_store_dwordx4 v[104:107], v194, s[60:63], s83 offen sc1
  s_add_u32 s83, s83, s84
  v_accvgpr_read_b32 v72, a88
  v_accvgpr_read_b32 v73, a89
  v_accvgpr_read_b32 v74, a90
  v_accvgpr_read_b32 v75, a91
  v_accvgpr_read_b32 v76, a92
  v_accvgpr_read_b32 v77, a93
  v_accvgpr_read_b32 v78, a94
  v_accvgpr_read_b32 v79, a95
  v_cvt_pk_bf16_f32 v108, v72, v73
  v_cvt_pk_bf16_f32 v109, v74, v75
  v_cvt_pk_bf16_f32 v110, v76, v77
  v_cvt_pk_bf16_f32 v111, v78, v79
  buffer_store_dwordx4 v[108:111], v194, s[60:63], s83 offen sc1
  s_add_u32 s83, s83, s84
  v_accvgpr_read_b32 v64, a96
  v_accvgpr_read_b32 v65, a97
  v_accvgpr_read_b32 v66, a98
  v_accvgpr_read_b32 v67, a99
  v_accvgpr_read_b32 v68, a100
  v_accvgpr_read_b32 v69, a101
  v_accvgpr_read_b32 v70, a102
  v_accvgpr_read_b32 v71, a103
  v_cvt_pk_bf16_f32 v96, v64, v65
  v_cvt_pk_bf16_f32 v97, v66, v67
  v_cvt_pk_bf16_f32 v98, v68, v69
  v_cvt_pk_bf16_f32 v99, v70, v71
  buffer_store_dwordx4 v[96:99], v194, s[60:63], s83 offen sc1
  s_add_u32 s83, s83, s84
  v_accvgpr_read_b32 v72, a104
  v_accvgpr_read_b32 v73, a105
  v_accvgpr_read_b32 v74, a106
  v_accvgpr_read_b32 v75, a107
  v_accvgpr_read_b32 v76, a108
  v_accvgpr_read_b32 v77, a109
  v_accvgpr_read_b32 v78, a110
  v_accvgpr_read_b32 v79, a111
  v_cvt_pk_bf16_f32 v100, v72, v73
  v_cvt_pk_bf16_f32 v101, v74, v75
  v_cvt_pk_bf16_f32 v102, v76, v77
  v_cvt_pk_bf16_f32 v103, v78, v79
  buffer_store_dwordx4 v[100:103], v194, s[60:63], s83 offen sc1
  s_add_u32 s83, s83, s84
  v_accvgpr_read_b32 v64, a112
  v_accvgpr_read_b32 v65, a113
  v_accvgpr_read_b32 v66, a114
  v_accvgpr_read_b32 v67, a115
  v_accvgpr_read_b32 v68, a116
  v_accvgpr_read_b32 v69, a117
  v_accvgpr_read_b32 v70, a118
  v_accvgpr_read_b32 v71, a119
  v_cvt_pk_bf16_f32 v104, v64, v65
  v_cvt_pk_bf16_f32 v105, v66, v67
  v_cvt_pk_bf16_f32 v106, v68, v69
  v_cvt_pk_bf16_f32 v107, v70, v71
  buffer_store_dwordx4 v[104:107], v194, s[60:63], s83 offen sc1
  s_add_u32 s83, s83, s84
  v_accvgpr_read_b32 v72, a120
  v_accvgpr_read_b32 v73, a121
  v_accvgpr_read_b32 v74, a122
  v_accvgpr_read_b32 v75, a123
  v_accvgpr_read_b32 v76, a124
  v_accvgpr_read_b32 v77, a125
  v_accvgpr_read_b32 v78, a126
  v_accvgpr_read_b32 v79, a127
  v_cvt_pk_bf16_f32 v108, v72, v73
  v_cvt_pk_bf16_f32 v109, v74, v75
  v_cvt_pk_bf16_f32 v110, v76, v77
  v_cvt_pk_bf16_f32 v111, v78, v79
  buffer_store_dwordx4 v[108:111], v194, s[60:63], s83 offen sc1
  s_add_u32 s83, s83, s84
  s_min_u32 s32, s81, 32
  s_lshl_b32 s33, s32, 2
  s_lshl_b32 s39, s38, 16
  s_lshl_b32 s40, s38, 11
  s_add_u32 s40, s40, 16777216
  s_mov_b32 s56, s14
  s_mov_b32 s57, s15
  s_mov_b32 s58, 2097152
  v_lshlrev_b32 v2, 4, v161
  v_and_b32 v3, 15, v161
  v_lshlrev_b32 v4, 8, v3
  v_lshlrev_b32 v3, 3, v3
  v_bfe_u32 v5, v161, 4, 1
  v_lshl_add_u32 v4, v5, 5, v4
  v_lshrrev_b32 v5, 5, v161
  v_lshl_add_u32 v4, v5, 4, v4
  v_mov_b32 v6, 1
  v_mov_b32 v7, 131072
  s_mov_b32 s34, s67
  s_mov_b32 s41, 0
  v_lshlrev_b32 v9, 7, v161
  s_lshl_b32 s83, s38, 7
  s_add_u32 s83, s83, 17301504
  v_cmp_gt_u32 s[84:85], s81, v161
  s_waitcnt vmcnt(0)
  v_readfirstlane_b32 s86, v201
  s_nop 1
  s_add_u32 s86, s86, s81
  s_barrier
  s_cmp_lg_u32 s20, 0
  s_cbranch_scc1 L_wait_others
  s_mov_b64 exec, s[84:85]
  buffer_atomic_add v6, v9, s[60:63], s83 offen sc1
  s_mov_b64 exec, 1
  v_mov_b32 v5, 1
  buffer_atomic_add v5, v206, s[48:51], s21 offen sc0 sc1
  s_mov_b32 s82, 204800
  s_waitcnt vmcnt(0)
  v_readfirstlane_b32 s83, v5
  s_nop 1
  s_add_u32 s83, s83, 1
  s_cmp_eq_u32 s83, s81
  s_cbranch_scc1 L_im_last
L_poll:
  buffer_load_dword v6, v206, s[60:63], s100 offen sc1
  s_waitcnt vmcnt(0)
  v_readfirstlane_b32 s83, v6
  s_nop 1
  s_cmp_eq_u32 s83, s86
  s_cbranch_scc1 L_go
  s_sleep 1
  s_sub_u32 s82, s82, 1
  s_and_b32 s83, s82, 31
  s_cbranch_scc1 L_poll
  buffer_load_dword v6, v206, s[48:51], s21 offen sc1
  s_waitcnt vmcnt(0)
  v_readfirstlane_b32 s83, v6
  s_nop 1
  s_cmp_eq_u32 s83, s81
  s_cbranch_scc1 L_go
  s_cmp_lg_u32 s82, 0
  s_cbranch_scc1 L_poll
L_giveup:
  s_lshl_b32 s83, 1, s67
  s_cmp_lt_u32 s67, 32
  s_cselect_b32 s83, s83, 0
  v_mov_b32 v6, s83
  buffer_atomic_or v6, v206, s[48:51], s21 offen offset:128 sc0 sc1
  s_waitcnt vmcnt(0)
  buffer_load_dword v6, v206, s[48:51], s21 offen sc1
  s_waitcnt vmcnt(0)
  v_readfirstlane_b32 s83, v6
  s_nop 1
  s_cmp_eq_u32 s83, s81
  s_cbranch_scc1 L_go
  v_mov_b32 v6, 2
  s_branch L_publish
L_im_early:
  v_mov_b32 v6, 3
  s_branch L_publish
L_im_last:
  v_mov_b32 v6, 1
  s_branch L_publish
L_go:
  v_mov_b32 v6, 0
L_publish:
  ds_write_b32 v7, v6
  s_mov_b64 exec, -1
  s_waitcnt lgkmcnt(0)
L_wait_others:
  s_barrier
  ds_read_b32 v6, v7
  s_waitcnt lgkmcnt(0)
  v_readfirstlane_b32 s37, v6
  s_nop 1
  s_cmp_eq_u32 s37, 2
  s_cbranch_scc1 L_fin
  buffer_load_dword v8, v206, s[48:51], s21 offen offset:128 sc1
  s_cmp_ge_u32 s34, s32
  s_cbranch_scc1 L_share_done
L_share:
  s_mul_i32 s35, s20, s32
  s_add_u32 s35, s35, s34
L_upass:
  s_cmp_ge_u32 s35, 64
  s_cbranch_scc1 L_share_done
  v_mov_b32 v10, 0xff800000
  v_mov_b32 v11, 0
  v_mov_b32 v12, 0
  v_mov_b32 v13, 0
  v_mov_b32 v14, 0
  v_mov_b32 v15, 0
  v_mov_b32 v16, 0
  v_mov_b32 v17, 0
  v_mov_b32 v18, 0
  v_mov_b32 v19, 0
  v_mov_b32 v20, 0xff800000
  v_mov_b32 v21, 0
  v_mov_b32 v22, 0
  v_mov_b32 v23, 0
  v_mov_b32 v24, 0
  v_mov_b32 v25, 0
  v_mov_b32 v26, 0
  v_mov_b32 v27, 0
  v_mov_b32 v28, 0
  v_mov_b32 v29, 0
  v_mov_b32 v30, 0xff800000
  v_mov_b32 v31, 0
  v_mov_b32 v32, 0
  v_mov_b32 v33, 0
  v_mov_b32 v34, 0
  v_mov_b32 v35, 0
  v_mov_b32 v36, 0
  v_mov_b32 v37, 0
  v_mov_b32 v38, 0
  v_mov_b32 v39, 0
  s_mov_b32 s36, 0
L_cpass:
  s_sub_u32 s90, s81, s36
  s_min_u32 s89, s90, 10
  s_lshl_b32 s89, s89, 1
  s_mov_b32 s92, 0
  s_mov_b32 s91, s35
  s_mul_i32 s83, s91, s81
  s_add_u32 s83, s83, s36
  s_lshl_b32 s83, s83, 10
  s_add_u32 s83, s83, s39
  s_lshr_b32 s84, s91, 3
  s_mul_i32 s84, s84, s81
  s_add_u32 s84, s84, s36
  s_lshl_b32 s84, s84, 8
  s_add_u32 s84, s84, s40
  s_and_b32 s85, s91, 4
  s_lshl_b32 s85, s85, 5
  s_add_u32 s84, s84, s85
  s_add_u32 s92, s92, s89
  buffer_load_dwordx2 v[162:163], v3, s[60:63], s84 offen offset:0 sc1
  buffer_load_dwordx4 v[40:43], v2, s[60:63], s83 offen offset:0 sc1
  s_cmp_le_u32 s90, 1
  s_cbranch_scc1 L_iss_0
  buffer_load_dwordx2 v[164:165], v3, s[60:63], s84 offen offset:256 sc1
  buffer_load_dwordx4 v[44:47], v2, s[60:63], s83 offen offset:1024 sc1
  s_cmp_le_u32 s90, 2
  s_cbranch_scc1 L_iss_0
  buffer_load_dwordx2 v[166:167], v3, s[60:63], s84 offen offset:512 sc1
  buffer_load_dwordx4 v[48:51], v2, s[60:63], s83 offen offset:2048 sc1
  s_cmp_le_u32 s90, 3
  s_cbranch_scc1 L_iss_0
  buffer_load_dwordx2 v[168:169], v3, s[60:63], s84 offen offset:768 sc1
  buffer_load_dwordx4 v[52:55], v2, s[60:63], s83 offen offset:3072 sc1
  s_cmp_le_u32 s90, 4
  s_cbranch_scc1 L_iss_0
  s_add_u32 s83, s83, 4096
  buffer_load_dwordx2 v[170:171], v3, s[60:63], s84 offen offset:1024 sc1
  buffer_load_dwordx4 v[56:59], v2, s[60:63], s83 offen offset:0 sc1
  s_cmp_le_u32 s90, 5
  s_cbranch_scc1 L_iss_0
  buffer_load_dwordx2 v[172:173], v3, s[60:63], s84 offen offset:1280 sc1
  buffer_load_dwordx4 v[60:63], v2, s[60:63], s83 offen offset:1024 sc1
  s_cmp_le_u32 s90, 6
  s_cbranch_scc1 L_iss_0
  buffer_load_dwordx2 v[174:175], v3, s[60:63], s84 offen offset:1536 sc1
  buffer_load_dwordx4 v[64:67], v2, s[60:63], s83 offen offset:2048 sc1
  s_cmp_le_u32 s90, 7
  s_cbranch_scc1 L_iss_0
  buffer_load_dwordx2 v[176:177], v3, s[60:63], s84 offen offset:1792 sc1
  buffer_load_dwordx4 v[68:71], v2, s[60:63], s83 offen offset:3072 sc1
  s_cmp_le_u32 s90, 8
  s_cbranch_scc1 L_iss_0
  s_add_u32 s83, s83, 4096
  buffer_load_dwordx2 v[178:179], v3, s[60:63], s84 offen offset:2048 sc1
  buffer_load_dwordx4 v[72:75], v2, s[60:63], s83 offen offset:0 sc1
  s_cmp_le_u32 s90, 9
  s_cbranch_scc1 L_iss_0
  buffer_load_dwordx2 v[180:181], v3, s[60:63], s84 offen offset:2304 sc1
  buffer_load_dwordx4 v[76:79], v2, s[60:63], s83 offen offset:1024 sc1
L_iss_0:
  s_add_u32 s91, s91, s33
  s_cmp_ge_u32 s91, 64
  s_cbranch_scc1 L_issued
  s_mul_i32 s83, s91, s81
  s_add_u32 s83, s83, s36
  s_lshl_b32 s83, s83, 10
  s_add_u32 s83, s83, s39
  s_lshr_b32 s84, s91, 3
  s_mul_i32 s84, s84, s81
  s_add_u32 s84, s84, s36
  s_lshl_b32 s84, s84, 8
  s_add_u32 s84, s84, s40
  s_and_b32 s85, s91, 4
  s_lshl_b32 s85, s85, 5
  s_add_u32 s84, s84, s85
  s_add_u32 s92, s92, s89
  buffer_load_dwordx2 v[182:183], v3, s[60:63], s84 offen offset:0 sc1
  buffer_load_dwordx4 v[80:83], v2, s[60:63], s83 offen offset:0 sc1
  s_cmp_le_u32 s90, 1
  s_cbranch_scc1 L_iss_1
  buffer_load_dwordx2 v[184:185], v3, s[60:63], s84 offen offset:256 sc1
  buffer_load_dwordx4 v[84:87], v2, s[60:63], s83 offen offset:1024 sc1
  s_cmp_le_u32 s90, 2
  s_cbranch_scc1 L_iss_1
  buffer_load_dwordx2 v[186:187], v3, s[60:63], s84 offen offset:512 sc1
  buffer_load_dwordx4 v[88:91], v2, s[60:63], s83 offen offset:2048 sc1
  s_cmp_le_u32 s90, 3
  s_cbranch_scc1 L_iss_1
  buffer_load_dwordx2 v[188:189], v3, s[60:63], s84 offen offset:768 sc1
  buffer_load_dwordx4 v[92:95], v2, s[60:63], s83 offen offset:3072 sc1
  s_cmp_le_u32 s90, 4
  s_cbranch_scc1 L_iss_1
  s_add_u32 s83, s83, 4096
  buffer_load_dwordx2 v[190:191], v3, s[60:63], s84 offen offset:1024 sc1
  buffer_load_dwordx4 v[96:99], v2, s[60:63], s83 offen offset:0 sc1
  s_cmp_le_u32 s90, 5
  s_cbranch_scc1 L_iss_1
  buffer_load_dwordx2 v[192:193], v3, s[60:63], s84 offen offset:1280 sc1
  buffer_load_dwordx4 v[100:103], v2, s[60:63], s83 offen offset:1024 sc1
  s_cmp_le_u32 s90, 6
  s_cbranch_scc1 L_iss_1
  buffer_load_dwordx2 v[194:195], v3, s[60:63], s84 offen offset:1536 sc1
  buffer_load_dwordx4 v[104:107], v2, s[60:63], s83 offen offset:2048 sc1
  s_cmp_le_u32 s90, 7
  s_cbranch_scc1 L_iss_1
  buffer_load_dwordx2 v[196:197], v3, s[60:63], s84 offen offset:1792 sc1
  buffer_load_dwordx4 v[108:111], v2, s[60:63], s83 offen offset:3072 sc1
  s_cmp_le_u32 s90, 8
  s_cbranch_scc1 L_iss_1
  s_add_u32 s83, s83, 4096
  buffer_load_dwordx2 v[198:199], v3, s[60:63], s84 offen offset:2048 sc1
  buffer_load_dwordx4 v[112:115], v2, s[60:63], s83 offen offset:0 sc1
  s_cmp_le_u32 s90, 9
  s_cbranch_scc1 L_iss_1
  buffer_load_dwordx2 v[232:233], v3, s[60:63], s84 offen offset:2304 sc1
  buffer_load_dwordx4 v[116:119], v2, s[60:63], s83 offen offset:1024 sc1
L_iss_1:
  s_add_u32 s91, s91, s33
  s_cmp_ge_u32 s91, 64
  s_cbranch_scc1 L_issued
  s_mul_i32 s83, s91, s81
  s_add_u32 s83, s83, s36
  s_lshl_b32 s83, s83, 10
  s_add_u32 s83, s83, s39
  s_lshr_b32 s84, s91, 3
  s_mul_i32 s84, s84, s81
  s_add_u32 s84, s84, s36
  s_lshl_b32 s84, s84, 8
  s_add_u32 s84, s84, s40
  s_and_b32 s85, s91, 4
  s_lshl_b32 s85, s85, 5
  s_add_u32 s84, s84, s85
  s_add_u32 s92, s92, s89
  buffer_load_dwordx2 v[234:235], v3, s[60:63], s84 offen offset:0 sc1
  buffer_load_dwordx4 v[120:123], v2, s[60:63], s83 offen offset:0 sc1
  s_cmp_le_u32 s90, 1
  s_cbranch_scc1 L_iss_2
  buffer_load_dwordx2 v[236:237], v3, s[60:63], s84 offen offset:256 sc1
  buffer_load_dwordx4 v[124:127], v2, s[60:63], s83 offen offset:1024 sc1
  s_cmp_le_u32 s90, 2
  s_cbranch_scc1 L_iss_2
  buffer_load_dwordx2 v[238:239], v3, s[60:63], s84 offen offset:512 sc1
  buffer_load_dwordx4 v[128:131], v2, s[60:63], s83 offen offset:2048 sc1
  s_cmp_le_u32 s90, 3
  s_cbranch_scc1 L_iss_2
  buffer_load_dwordx2 v[240:241], v3, s[60:63], s84 offen offset:768 sc1
  buffer_load_dwordx4 v[132:135], v2, s[60:63], s83 offen offset:3072 sc1
  s_cmp_le_u32 s90, 4
  s_cbranch_scc1 L_iss_2
  s_add_u32 s83, s83, 4096
  buffer_load_dwordx2 v[242:243], v3, s[60:63], s84 offen offset:1024 sc1
  buffer_load_dwordx4 v[136:139], v2, s[60:63], s83 offen offset:0 sc1
  s_cmp_le_u32 s90, 5
  s_cbranch_scc1 L_iss_2
  buffer_load_dwordx2 v[244:245], v3, s[60:63], s84 offen offset:1280 sc1
  buffer_load_dwordx4 v[140:143], v2, s[60:63], s83 offen offset:1024 sc1
  s_cmp_le_u32 s90, 6
  s_cbranch_scc1 L_iss_2
  buffer_load_dwordx2 v[246:247], v3, s[60:63], s84 offen offset:1536 sc1
  buffer_load_dwordx4 v[144:147], v2, s[60:63], s83 offen offset:2048 sc1
  s_cmp_le_u32 s90, 7
  s_cbranch_scc1 L_iss_2
  buffer_load_dwordx2 v[248:249], v3, s[60:63], s84 offen offset:1792 sc1
  buffer_load_dwordx4 v[148:151], v2, s[60:63], s83 offen offset:3072 sc1
  s_cmp_le_u32 s90, 8
  s_cbranch_scc1 L_iss_2
  s_add_u32 s83, s83, 4096
  buffer_load_dwordx2 v[250:251], v3, s[60:63], s84 offen offset:2048 sc1
  buffer_load_dwordx4 v[152:155], v2, s[60:63], s83 offen offset:0 sc1
  s_cmp_le_u32 s90, 9
  s_cbranch_scc1 L_iss_2
  buffer_load_dwordx2 v[252:253], v3, s[60:63], s84 offen offset:2304 sc1
  buffer_load_dwordx4 v[156:159], v2, s[60:63], s83 offen offset:1024 sc1
L_iss_2:
L_issued:
  s_mov_b32 s91, s35
  s_sub_u32 s92, s92, s89
  s_cmp_ge_u32 s92, 40
  s_cbranch_scc1 L_w0_40
  s_cmp_ge_u32 s92, 32
  s_cbranch_scc1 L_w0_32
  s_cmp_ge_u32 s92, 28
  s_cbranch_scc1 L_w0_28
  s_cmp_ge_u32 s92, 24
  s_cbranch_scc1 L_w0_24
  s_cmp_ge_u32 s92, 20
  s_cbranch_scc1 L_w0_20
  s_cmp_ge_u32 s92, 18
  s_cbranch_scc1 L_w0_18
  s_cmp_ge_u32 s92, 16
  s_cbranch_scc1 L_w0_16
  s_cmp_ge_u32 s92, 14
  s_cbranch_scc1 L_w0_14
  s_cmp_ge_u32 s92, 12
  s_cbranch_scc1 L_w0_12
  s_cmp_ge_u32 s92, 8
  s_cbranch_scc1 L_w0_8
  s_cmp_ge_u32 s92, 4
  s_cbranch_scc1 L_w0_4
  s_waitcnt vmcnt(0)
  s_branch L_wd0
L_w0_40:
  s_waitcnt vmcnt(40)
  s_branch L_wd0
L_w0_32:
  s_waitcnt vmcnt(32)
  s_branch L_wd0
L_w0_28:
  s_waitcnt vmcnt(28)
  s_branch L_wd0
L_w0_24:
  s_waitcnt vmcnt(24)
  s_branch L_wd0
L_w0_20:
  s_waitcnt vmcnt(20)
  s_branch L_wd0
L_w0_18:
  s_waitcnt vmcnt(18)
  s_branch L_wd0
L_w0_16:
  s_waitcnt vmcnt(16)
  s_branch L_wd0
L_w0_14:
  s_waitcnt vmcnt(14)
  s_branch L_wd0
L_w0_12:
  s_waitcnt vmcnt(12)
  s_branch L_wd0
L_w0_8:
  s_waitcnt vmcnt(8)
  s_branch L_wd0
L_w0_4:
  s_waitcnt vmcnt(4)
  s_branch L_wd0
L_wd0:
  v_max_f32 v5, v10, v162
  s_cmp_le_u32 s90, 1
  s_cbranch_scc1 L_mx_0
  v_max_f32 v5, v5, v164
  s_cmp_le_u32 s90, 2
  s_cbranch_scc1 L_mx_0
  v_max_f32 v5, v5, v166
  s_cmp_le_u32 s90, 3
  s_cbranch_scc1 L_mx_0
  v_max_f32 v5, v5, v168
  s_cmp_le_u32 s90, 4
  s_cbranch_scc1 L_mx_0
  v_max_f32 v5, v5, v170
  s_cmp_le_u32 s90, 5
  s_cbranch_scc1 L_mx_0
  v_max_f32 v5, v5, v172
  s_cmp_le_u32 s90, 6
  s_cbranch_scc1 L_mx_0
  v_max_f32 v5, v5, v174
  s_cmp_le_u32 s90, 7
  s_cbranch_scc1 L_mx_0
  v_max_f32 v5, v5, v176
  s_cmp_le_u32 s90, 8
  s_cbranch_scc1 L_mx_0
  v_max_f32 v5, v5, v178
  s_cmp_le_u32 s90, 9
  s_cbranch_scc1 L_mx_0
  v_max_f32 v5, v5, v180
L_mx_0:
  v_sub_f32 v6, v10, v5
  v_exp_f32 v6, v6
  v_mov_b32 v10, v5
  v_mov_b32 v7, v6
  v_mul_f32 v11, v11, v6
  v_pk_mul_f32 v[12:13], v[12:13], v[6:7]
  v_pk_mul_f32 v[14:15], v[14:15], v[6:7]
  v_pk_mul_f32 v[16:17], v[16:17], v[6:7]
  v_pk_mul_f32 v[18:19], v[18:19], v[6:7]
  v_sub_f32 v6, v162, v5
  v_exp_f32 v6, v6
  v_lshlrev_b32 v220, 16, v40
  v_and_b32 v221, 0xffff0000, v40
  v_lshlrev_b32 v222, 16, v41
  v_and_b32 v223, 0xffff0000, v41
  v_lshlrev_b32 v224, 16, v42
  v_and_b32 v225, 0xffff0000, v42
  v_lshlrev_b32 v226, 16, v43
  v_and_b32 v227, 0xffff0000, v43
  v_fmac_f32 v11, v6, v163
  v_pk_fma_f32 v[12:13], v[220:221], v[6:7], v[12:13] op_sel_hi:[1,0,1]
  v_pk_fma_f32 v[14:15], v[222:223], v[6:7], v[14:15] op_sel_hi:[1,0,1]
  v_pk_fma_f32 v[16:17], v[224:225], v[6:7], v[16:17] op_sel_hi:[1,0,1]
  v_pk_fma_f32 v[18:19], v[226:227], v[6:7], v[18:19] op_sel_hi:[1,0,1]
  s_cmp_le_u32 s90, 1
  s_cbranch_scc1 L_ac_0
  v_sub_f32 v6, v164, v5
  v_exp_f32 v6, v6
  v_lshlrev_b32 v220, 16, v44
  v_and_b32 v221, 0xffff0000, v44
  v_lshlrev_b32 v222, 16, v45
  v_and_b32 v223, 0xffff0000, v45
  v_lshlrev_b32 v224, 16, v46
  v_and_b32 v225, 0xffff0000, v46
  v_lshlrev_b32 v226, 16, v47
  v_and_b32 v227, 0xffff0000, v47
  v_fmac_f32 v11, v6, v165
  v_pk_fma_f32 v[12:13], v[220:221], v[6:7], v[12:13] op_sel_hi:[1,0,1]
  v_pk_fma_f32 v[14:15], v[222:223], v[6:7], v[14:15] op_sel_hi:[1,0,1]
  v_pk_fma_f32 v[16:17], v[224:225], v[6:7], v[16:17] op_sel_hi:[1,0,1]
  v_pk_fma_f32 v[18:19], v[226:227], v[6:7], v[18:19] op_sel_hi:[1,0,1]
  s_cmp_le_u32 s90, 2
  s_cbranch_scc1 L_ac_0
  v_sub_f32 v6, v166, v5
  v_exp_f32 v6, v6
  v_lshlrev_b32 v220, 16, v48
  v_and_b32 v221, 0xffff0000, v48
  v_lshlrev_b32 v222, 16, v49
  v_and_b32 v223, 0xffff0000, v49
  v_lshlrev_b32 v224, 16, v50
  v_and_b32 v225, 0xffff0000, v50
  v_lshlrev_b32 v226, 16, v51
  v_and_b32 v227, 0xffff0000, v51
  v_fmac_f32 v11, v6, v167
  v_pk_fma_f32 v[12:13], v[220:221], v[6:7], v[12:13] op_sel_hi:[1,0,1]
  v_pk_fma_f32 v[14:15], v[222:223], v[6:7], v[14:15] op_sel_hi:[1,0,1]
  v_pk_fma_f32 v[16:17], v[224:225], v[6:7], v[16:17] op_sel_hi:[1,0,1]
  v_pk_fma_f32 v[18:19], v[226:227], v[6:7], v[18:19] op_sel_hi:[1,0,1]
  s_cmp_le_u32 s90, 3
  s_cbranch_scc1 L_ac_0
  v_sub_f32 v6, v168, v5
  v_exp_f32 v6, v6
  v_lshlrev_b32 v220, 16, v52
  v_and_b32 v221, 0xffff0000, v52
  v_lshlrev_b32 v222, 16, v53
  v_and_b32 v223, 0xffff0000, v53
  v_lshlrev_b32 v224, 16, v54
  v_and_b32 v225, 0xffff0000, v54
  v_lshlrev_b32 v226, 16, v55
  v_and_b32 v227, 0xffff0000, v55
  v_fmac_f32 v11, v6, v169
  v_pk_fma_f32 v[12:13], v[220:221], v[6:7], v[12:13] op_sel_hi:[1,0,1]
  v_pk_fma_f32 v[14:15], v[222:223], v[6:7], v[14:15] op_sel_hi:[1,0,1]
  v_pk_fma_f32 v[16:17], v[224:225], v[6:7], v[16:17] op_sel_hi:[1,0,1]
  v_pk_fma_f32 v[18:19], v[226:227], v[6:7], v[18:19] op_sel_hi:[1,0,1]
  s_cmp_le_u32 s90, 4
  s_cbranch_scc1 L_ac_0
  v_sub_f32 v6, v170, v5
  v_exp_f32 v6, v6
  v_lshlrev_b32 v220, 16, v56
  v_and_b32 v221, 0xffff0000, v56
  v_lshlrev_b32 v222, 16, v57
  v_and_b32 v223, 0xffff0000, v57
  v_lshlrev_b32 v224, 16, v58
  v_and_b32 v225, 0xffff0000, v58
  v_lshlrev_b32 v226, 16, v59
  v_and_b32 v227, 0xffff0000, v59
  v_fmac_f32 v11, v6, v171
  v_pk_fma_f32 v[12:13], v[220:221], v[6:7], v[12:13] op_sel_hi:[1,0,1]
  v_pk_fma_f32 v[14:15], v[222:223], v[6:7], v[14:15] op_sel_hi:[1,0,1]
  v_pk_fma_f32 v[16:17], v[224:225], v[6:7], v[16:17] op_sel_hi:[1,0,1]
  v_pk_fma_f32 v[18:19], v[226:227], v[6:7], v[18:19] op_sel_hi:[1,0,1]
  s_cmp_le_u32 s90, 5
  s_cbranch_scc1 L_ac_0
  v_sub_f32 v6, v172, v5
  v_exp_f32 v6, v6
  v_lshlrev_b32 v220, 16, v60
  v_and_b32 v221, 0xffff0000, v60
  v_lshlrev_b32 v222, 16, v61
  v_and_b32 v223, 0xffff0000, v61
  v_lshlrev_b32 v224, 16, v62
  v_and_b32 v225, 0xffff0000, v62
  v_lshlrev_b32 v226, 16, v63
  v_and_b32 v227, 0xffff0000, v63
  v_fmac_f32 v11, v6, v173
  v_pk_fma_f32 v[12:13], v[220:221], v[6:7], v[12:13] op_sel_hi:[1,0,1]
  v_pk_fma_f32 v[14:15], v[222:223], v[6:7], v[14:15] op_sel_hi:[1,0,1]
  v_pk_fma_f32 v[16:17], v[224:225], v[6:7], v[16:17] op_sel_hi:[1,0,1]
  v_pk_fma_f32 v[18:19], v[226:227], v[6:7], v[18:19] op_sel_hi:[1,0,1]
  s_cmp_le_u32 s90, 6
  s_cbranch_scc1 L_ac_0
  v_sub_f32 v6, v174, v5
  v_exp_f32 v6, v6
  v_lshlrev_b32 v220, 16, v64
  v_and_b32 v221, 0xffff0000, v64
  v_lshlrev_b32 v222, 16, v65
  v_and_b32 v223, 0xffff0000, v65
  v_lshlrev_b32 v224, 16, v66
  v_and_b32 v225, 0xffff0000, v66
  v_lshlrev_b32 v226, 16, v67
  v_and_b32 v227, 0xffff0000, v67
  v_fmac_f32 v11, v6, v175
  v_pk_fma_f32 v[12:13], v[220:221], v[6:7], v[12:13] op_sel_hi:[1,0,1]
  v_pk_fma_f32 v[14:15], v[222:223], v[6:7], v[14:15] op_sel_hi:[1,0,1]
  v_pk_fma_f32 v[16:17], v[224:225], v[6:7], v[16:17] op_sel_hi:[1,0,1]
  v_pk_fma_f32 v[18:19], v[226:227], v[6:7], v[18:19] op_sel_hi:[1,0,1]
  s_cmp_le_u32 s90, 7
  s_cbranch_scc1 L_ac_0
  v_sub_f32 v6, v176, v5
  v_exp_f32 v6, v6
  v_lshlrev_b32 v220, 16, v68
  v_and_b32 v221, 0xffff0000, v68
  v_lshlrev_b32 v222, 16, v69
  v_and_b32 v223, 0xffff0000, v69
  v_lshlrev_b32 v224, 16, v70
  v_and_b32 v225, 0xffff0000, v70
  v_lshlrev_b32 v226, 16, v71
  v_and_b32 v227, 0xffff0000, v71
  v_fmac_f32 v11, v6, v177
  v_pk_fma_f32 v[12:13], v[220:221], v[6:7], v[12:13] op_sel_hi:[1,0,1]
  v_pk_fma_f32 v[14:15], v[222:223], v[6:7], v[14:15] op_sel_hi:[1,0,1]
  v_pk_fma_f32 v[16:17], v[224:225], v[6:7], v[16:17] op_sel_hi:[1,0,1]
  v_pk_fma_f32 v[18:19], v[226:227], v[6:7], v[18:19] op_sel_hi:[1,0,1]
  s_cmp_le_u32 s90, 8
  s_cbranch_scc1 L_ac_0
  v_sub_f32 v6, v178, v5
  v_exp_f32 v6, v6
  v_lshlrev_b32 v220, 16, v72
  v_and_b32 v221, 0xffff0000, v72
  v_lshlrev_b32 v222, 16, v73
  v_and_b32 v223, 0xffff0000, v73
  v_lshlrev_b32 v224, 16, v74
  v_and_b32 v225, 0xffff0000, v74
  v_lshlrev_b32 v226, 16, v75
  v_and_b32 v227, 0xffff0000, v75
  v_fmac_f32 v11, v6, v179
  v_pk_fma_f32 v[12:13], v[220:221], v[6:7], v[12:13] op_sel_hi:[1,0,1]
  v_pk_fma_f32 v[14:15], v[222:223], v[6:7], v[14:15] op_sel_hi:[1,0,1]
  v_pk_fma_f32 v[16:17], v[224:225], v[6:7], v[16:17] op_sel_hi:[1,0,1]
  v_pk_fma_f32 v[18:19], v[226:227], v[6:7], v[18:19] op_sel_hi:[1,0,1]
  s_cmp_le_u32 s90, 9
  s_cbranch_scc1 L_ac_0
  v_sub_f32 v6, v180, v5
  v_exp_f32 v6, v6
  v_lshlrev_b32 v220, 16, v76
  v_and_b32 v221, 0xffff0000, v76
  v_lshlrev_b32 v222, 16, v77
  v_and_b32 v223, 0xffff0000, v77
  v_lshlrev_b32 v224, 16, v78
  v_and_b32 v225, 0xffff0000, v78
  v_lshlrev_b32 v226, 16, v79
  v_and_b32 v227, 0xffff0000, v79
  v_fmac_f32 v11, v6, v181
  v_pk_fma_f32 v[12:13], v[220:221], v[6:7], v[12:13] op_sel_hi:[1,0,1]
  v_pk_fma_f32 v[14:15], v[222:223], v[6:7], v[14:15] op_sel_hi:[1,0,1]
  v_pk_fma_f32 v[16:17], v[224:225], v[6:7], v[16:17] op_sel_hi:[1,0,1]
  v_pk_fma_f32 v[18:19], v[226:227], v[6:7], v[18:19] op_sel_hi:[1,0,1]
L_ac_0:
  s_add_u32 s91, s91, s33
  s_cmp_ge_u32 s91, 64
  s_cbranch_scc1 L_mathed
  s_sub_u32 s92, s92, s89
  s_cmp_ge_u32 s92, 20
  s_cbranch_scc1 L_w1_20
  s_cmp_ge_u32 s92, 18
  s_cbranch_scc1 L_w1_18
  s_cmp_ge_u32 s92, 16
  s_cbranch_scc1 L_w1_16
  s_cmp_ge_u32 s92, 14
  s_cbranch_scc1 L_w1_14
  s_cmp_ge_u32 s92, 12
  s_cbranch_scc1 L_w1_12
  s_cmp_ge_u32 s92, 8
  s_cbranch_scc1 L_w1_8
  s_cmp_ge_u32 s92, 4
  s_cbranch_scc1 L_w1_4
  s_waitcnt vmcnt(0)
  s_branch L_wd1
L_w1_20:
  s_waitcnt vmcnt(20)
  s_branch L_wd1
L_w1_18:
  s_waitcnt vmcnt(18)
  s_branch L_wd1
L_w1_16:
  s_waitcnt vmcnt(16)
  s_branch L_wd1
L_w1_14:
  s_waitcnt vmcnt(14)
  s_branch L_wd1
L_w1_12:
  s_waitcnt vmcnt(12)
  s_branch L_wd1
L_w1_8:
  s_waitcnt vmcnt(8)
  s_branch L_wd1
L_w1_4:
  s_waitcnt vmcnt(4)
  s_branch L_wd1
L_wd1:
  v_max_f32 v5, v20, v182
  s_cmp_le_u32 s90, 1
  s_cbranch_scc1 L_mx_1
  v_max_f32 v5, v5, v184
  s_cmp_le_u32 s90, 2
  s_cbranch_scc1 L_mx_1
  v_max_f32 v5, v5, v186
  s_cmp_le_u32 s90, 3
  s_cbranch_scc1 L_mx_1
  v_max_f32 v5, v5, v188
  s_cmp_le_u32 s90, 4
  s_cbranch_scc1 L_mx_1
  v_max_f32 v5, v5, v190
  s_cmp_le_u32 s90, 5
  s_cbranch_scc1 L_mx_1
  v_max_f32 v5, v5, v192
  s_cmp_le_u32 s90, 6
  s_cbranch_scc1 L_mx_1
  v_max_f32 v5, v5, v194
  s_cmp_le_u32 s90, 7
  s_cbranch_scc1 L_mx_1
  v_max_f32 v5, v5, v196
  s_cmp_le_u32 s90, 8
  s_cbranch_scc1 L_mx_1
  v_max_f32 v5, v5, v198
  s_cmp_le_u32 s90, 9
  s_cbranch_scc1 L_mx_1
  v_max_f32 v5, v5, v232
L_mx_1:
  v_sub_f32 v6, v20, v5
  v_exp_f32 v6, v6
  v_mov_b32 v20, v5
  v_mov_b32 v7, v6
  v_mul_f32 v21, v21, v6
  v_pk_mul_f32 v[22:23], v[22:23], v[6:7]
  v_pk_mul_f32 v[24:25], v[24:25], v[6:7]
  v_pk_mul_f32 v[26:27], v[26:27], v[6:7]
  v_pk_mul_f32 v[28:29], v[28:29], v[6:7]
  v_sub_f32 v6, v182, v5
  v_exp_f32 v6, v6
  v_lshlrev_b32 v220, 16, v80
  v_and_b32 v221, 0xffff0000, v80
  v_lshlrev_b32 v222, 16, v81
  v_and_b32 v223, 0xffff0000, v81
  v_lshlrev_b32 v224, 16, v82
  v_and_b32 v225, 0xffff0000, v82
  v_lshlrev_b32 v226, 16, v83
  v_and_b32 v227, 0xffff0000, v83
  v_fmac_f32 v21, v6, v183
  v_pk_fma_f32 v[22:23], v[220:221], v[6:7], v[22:23] op_sel_hi:[1,0,1]
  v_pk_fma_f32 v[24:25], v[222:223], v[6:7], v[24:25] op_sel_hi:[1,0,1]
  v_pk_fma_f32 v[26:27], v[224:225], v[6:7], v[26:27] op_sel_hi:[1,0,1]
  v_pk_fma_f32 v[28:29], v[226:227], v[6:7], v[28:29] op_sel_hi:[1,0,1]
  s_cmp_le_u32 s90, 1
  s_cbranch_scc1 L_ac_1
  v_sub_f32 v6, v184, v5
  v_exp_f32 v6, v6
  v_lshlrev_b32 v220, 16, v84
  v_and_b32 v221, 0xffff0000, v84
  v_lshlrev_b32 v222, 16, v85
  v_and_b32 v223, 0xffff0000, v85
  v_lshlrev_b32 v224, 16, v86
  v_and_b32 v225, 0xffff0000, v86
  v_lshlrev_b32 v226, 16, v87
  v_and_b32 v227, 0xffff0000, v87
  v_fmac_f32 v21, v6, v185
  v_pk_fma_f32 v[22:23], v[220:221], v[6:7], v[22:23] op_sel_hi:[1,0,1]
  v_pk_fma_f32 v[24:25], v[222:223], v[6:7], v[24:25] op_sel_hi:[1,0,1]
  v_pk_fma_f32 v[26:27], v[224:225], v[6:7], v[26:27] op_sel_hi:[1,0,1]
  v_pk_fma_f32 v[28:29], v[226:227], v[6:7], v[28:29] op_sel_hi:[1,0,1]
  s_cmp_le_u32 s90, 2
  s_cbranch_scc1 L_ac_1
  v_sub_f32 v6, v186, v5
  v_exp_f32 v6, v6
  v_lshlrev_b32 v220, 16, v88
  v_and_b32 v221, 0xffff0000, v88
  v_lshlrev_b32 v222, 16, v89
  v_and_b32 v223, 0xffff0000, v89
  v_lshlrev_b32 v224, 16, v90
  v_and_b32 v225, 0xffff0000, v90
  v_lshlrev_b32 v226, 16, v91
  v_and_b32 v227, 0xffff0000, v91
  v_fmac_f32 v21, v6, v187
  v_pk_fma_f32 v[22:23], v[220:221], v[6:7], v[22:23] op_sel_hi:[1,0,1]
  v_pk_fma_f32 v[24:25], v[222:223], v[6:7], v[24:25] op_sel_hi:[1,0,1]
  v_pk_fma_f32 v[26:27], v[224:225], v[6:7], v[26:27] op_sel_hi:[1,0,1]
  v_pk_fma_f32 v[28:29], v[226:227], v[6:7], v[28:29] op_sel_hi:[1,0,1]
  s_cmp_le_u32 s90, 3
  s_cbranch_scc1 L_ac_1
  v_sub_f32 v6, v188, v5
  v_exp_f32 v6, v6
  v_lshlrev_b32 v220, 16, v92
  v_and_b32 v221, 0xffff0000, v92
  v_lshlrev_b32 v222, 16, v93
  v_and_b32 v223, 0xffff0000, v93
  v_lshlrev_b32 v224, 16, v94
  v_and_b32 v225, 0xffff0000, v94
  v_lshlrev_b32 v226, 16, v95
  v_and_b32 v227, 0xffff0000, v95
  v_fmac_f32 v21, v6, v189
  v_pk_fma_f32 v[22:23], v[220:221], v[6:7], v[22:23] op_sel_hi:[1,0,1]
  v_pk_fma_f32 v[24:25], v[222:223], v[6:7], v[24:25] op_sel_hi:[1,0,1]
  v_pk_fma_f32 v[26:27], v[224:225], v[6:7], v[26:27] op_sel_hi:[1,0,1]
  v_pk_fma_f32 v[28:29], v[226:227], v[6:7], v[28:29] op_sel_hi:[1,0,1]
  s_cmp_le_u32 s90, 4
  s_cbranch_scc1 L_ac_1
  v_sub_f32 v6, v190, v5
  v_exp_f32 v6, v6
  v_lshlrev_b32 v220, 16, v96
  v_and_b32 v221, 0xffff0000, v96
  v_lshlrev_b32 v222, 16, v97
  v_and_b32 v223, 0xffff0000, v97
  v_lshlrev_b32 v224, 16, v98
  v_and_b32 v225, 0xffff0000, v98
  v_lshlrev_b32 v226, 16, v99
  v_and_b32 v227, 0xffff0000, v99
  v_fmac_f32 v21, v6, v191
  v_pk_fma_f32 v[22:23], v[220:221], v[6:7], v[22:23] op_sel_hi:[1,0,1]
  v_pk_fma_f32 v[24:25], v[222:223], v[6:7], v[24:25] op_sel_hi:[1,0,1]
  v_pk_fma_f32 v[26:27], v[224:225], v[6:7], v[26:27] op_sel_hi:[1,0,1]
  v_pk_fma_f32 v[28:29], v[226:227], v[6:7], v[28:29] op_sel_hi:[1,0,1]
  s_cmp_le_u32 s90, 5
  s_cbranch_scc1 L_ac_1
  v_sub_f32 v6, v192, v5
  v_exp_f32 v6, v6
  v_lshlrev_b32 v220, 16, v100
  v_and_b32 v221, 0xffff0000, v100
  v_lshlrev_b32 v222, 16, v101
  v_and_b32 v223, 0xffff0000, v101
  v_lshlrev_b32 v224, 16, v102
  v_and_b32 v225, 0xffff0000, v102
  v_lshlrev_b32 v226, 16, v103
  v_and_b32 v227, 0xffff0000, v103
  v_fmac_f32 v21, v6, v193
  v_pk_fma_f32 v[22:23], v[220:221], v[6:7], v[22:23] op_sel_hi:[1,0,1]
  v_pk_fma_f32 v[24:25], v[222:223], v[6:7], v[24:25] op_sel_hi:[1,0,1]
  v_pk_fma_f32 v[26:27], v[224:225], v[6:7], v[26:27] op_sel_hi:[1,0,1]
  v_pk_fma_f32 v[28:29], v[226:227], v[6:7], v[28:29] op_sel_hi:[1,0,1]
  s_cmp_le_u32 s90, 6
  s_cbranch_scc1 L_ac_1
  v_sub_f32 v6, v194, v5
  v_exp_f32 v6, v6
  v_lshlrev_b32 v220, 16, v104
  v_and_b32 v221, 0xffff0000, v104
  v_lshlrev_b32 v222, 16, v105
  v_and_b32 v223, 0xffff0000, v105
  v_lshlrev_b32 v224, 16, v106
  v_and_b32 v225, 0xffff0000, v106
  v_lshlrev_b32 v226, 16, v107
  v_and_b32 v227, 0xffff0000, v107
  v_fmac_f32 v21, v6, v195
  v_pk_fma_f32 v[22:23], v[220:221], v[6:7], v[22:23] op_sel_hi:[1,0,1]
  v_pk_fma_f32 v[24:25], v[222:223], v[6:7], v[24:25] op_sel_hi:[1,0,1]
  v_pk_fma_f32 v[26:27], v[224:225], v[6:7], v[26:27] op_sel_hi:[1,0,1]
  v_pk_fma_f32 v[28:29], v[226:227], v[6:7], v[28:29] op_sel_hi:[1,0,1]
  s_cmp_le_u32 s90, 7
  s_cbranch_scc1 L_ac_1
  v_sub_f32 v6, v196, v5
  v_exp_f32 v6, v6
  v_lshlrev_b32 v220, 16, v108
  v_and_b32 v221, 0xffff0000, v108
  v_lshlrev_b32 v222, 16, v109
  v_and_b32 v223, 0xffff0000, v109
  v_lshlrev_b32 v224, 16, v110
  v_and_b32 v225, 0xffff0000, v110
  v_lshlrev_b32 v226, 16, v111
  v_and_b32 v227, 0xffff0000, v111
  v_fmac_f32 v21, v6, v197
  v_pk_fma_f32 v[22:23], v[220:221], v[6:7], v[22:23] op_sel_hi:[1,0,1]
  v_pk_fma_f32 v[24:25], v[222:223], v[6:7], v[24:25] op_sel_hi:[1,0,1]
  v_pk_fma_f32 v[26:27], v[224:225], v[6:7], v[26:27] op_sel_hi:[1,0,1]
  v_pk_fma_f32 v[28:29], v[226:227], v[6:7], v[28:29] op_sel_hi:[1,0,1]
  s_cmp_le_u32 s90, 8
  s_cbranch_scc1 L_ac_1
  v_sub_f32 v6, v198, v5
  v_exp_f32 v6, v6
  v_lshlrev_b32 v220, 16, v112
  v_and_b32 v221, 0xffff0000, v112
  v_lshlrev_b32 v222, 16, v113
  v_and_b32 v223, 0xffff0000, v113
  v_lshlrev_b32 v224, 16, v114
  v_and_b32 v225, 0xffff0000, v114
  v_lshlrev_b32 v226, 16, v115
  v_and_b32 v227, 0xffff0000, v115
  v_fmac_f32 v21, v6, v199
  v_pk_fma_f32 v[22:23], v[220:221], v[6:7], v[22:23] op_sel_hi:[1,0,1]
  v_pk_fma_f32 v[24:25], v[222:223], v[6:7], v[24:25] op_sel_hi:[1,0,1]
  v_pk_fma_f32 v[26:27], v[224:225], v[6:7], v[26:27] op_sel_hi:[1,0,1]
  v_pk_fma_f32 v[28:29], v[226:227], v[6:7], v[28:29] op_sel_hi:[1,0,1]
  s_cmp_le_u32 s90, 9
  s_cbranch_scc1 L_ac_1
  v_sub_f32 v6, v232, v5
  v_exp_f32 v6, v6
  v_lshlrev_b32 v220, 16, v116
  v_and_b32 v221, 0xffff0000, v116
  v_lshlrev_b32 v222, 16, v117
  v_and_b32 v223, 0xffff0000, v117
  v_lshlrev_b32 v224, 16, v118
  v_and_b32 v225, 0xffff0000, v118
  v_lshlrev_b32 v226, 16, v119
  v_and_b32 v227, 0xffff0000, v119
  v_fmac_f32 v21, v6, v233
  v_pk_fma_f32 v[22:23], v[220:221], v[6:7], v[22:23] op_sel_hi:[1,0,1]
  v_pk_fma_f32 v[24:25], v[222:223], v[6:7], v[24:25] op_sel_hi:[1,0,1]
  v_pk_fma_f32 v[26:27], v[224:225], v[6:7], v[26:27] op_sel_hi:[1,0,1]
  v_pk_fma_f32 v[28:29], v[226:227], v[6:7], v[28:29] op_sel_hi:[1,0,1]
L_ac_1:
  s_add_u32 s91, s91, s33
  s_cmp_ge_u32 s91, 64
  s_cbranch_scc1 L_mathed
  s_sub_u32 s92, s92, s89
  s_waitcnt vmcnt(0)
  v_max_f32 v5, v30, v234
  s_cmp_le_u32 s90, 1
  s_cbranch_scc1 L_mx_2
  v_max_f32 v5, v5, v236
  s_cmp_le_u32 s90, 2
  s_cbranch_scc1 L_mx_2
  v_max_f32 v5, v5, v238
  s_cmp_le_u32 s90, 3
  s_cbranch_scc1 L_mx_2
  v_max_f32 v5, v5, v240
  s_cmp_le_u32 s90, 4
  s_cbranch_scc1 L_mx_2
  v_max_f32 v5, v5, v242
  s_cmp_le_u32 s90, 5
  s_cbranch_scc1 L_mx_2
  v_max_f32 v5, v5, v244
  s_cmp_le_u32 s90, 6
  s_cbranch_scc1 L_mx_2
  v_max_f32 v5, v5, v246
  s_cmp_le_u32 s90, 7
  s_cbranch_scc1 L_mx_2
  v_max_f32 v5, v5, v248
  s_cmp_le_u32 s90, 8
  s_cbranch_scc1 L_mx_2
  v_max_f32 v5, v5, v250
  s_cmp_le_u32 s90, 9
  s_cbranch_scc1 L_mx_2
  v_max_f32 v5, v5, v252
L_mx_2:
  v_sub_f32 v6, v30, v5
  v_exp_f32 v6, v6
  v_mov_b32 v30, v5
  v_mov_b32 v7, v6
  v_mul_f32 v31, v31, v6
  v_pk_mul_f32 v[32:33], v[32:33], v[6:7]
  v_pk_mul_f32 v[34:35], v[34:35], v[6:7]
  v_pk_mul_f32 v[36:37], v[36:37], v[6:7]
  v_pk_mul_f32 v[38:39], v[38:39], v[6:7]
  v_sub_f32 v6, v234, v5
  v_exp_f32 v6, v6
  v_lshlrev_b32 v220, 16, v120
  v_and_b32 v221, 0xffff0000, v120
  v_lshlrev_b32 v222, 16, v121
  v_and_b32 v223, 0xffff0000, v121
  v_lshlrev_b32 v224, 16, v122
  v_and_b32 v225, 0xffff0000, v122
  v_lshlrev_b32 v226, 16, v123
  v_and_b32 v227, 0xffff0000, v123
  v_fmac_f32 v31, v6, v235
  v_pk_fma_f32 v[32:33], v[220:221], v[6:7], v[32:33] op_sel_hi:[1,0,1]
  v_pk_fma_f32 v[34:35], v[222:223], v[6:7], v[34:35] op_sel_hi:[1,0,1]
  v_pk_fma_f32 v[36:37], v[224:225], v[6:7], v[36:37] op_sel_hi:[1,0,1]
  v_pk_fma_f32 v[38:39], v[226:227], v[6:7], v[38:39] op_sel_hi:[1,0,1]
  s_cmp_le_u32 s90, 1
  s_cbranch_scc1 L_ac_2
  v_sub_f32 v6, v236, v5
  v_exp_f32 v6, v6
  v_lshlrev_b32 v220, 16, v124
  v_and_b32 v221, 0xffff0000, v124
  v_lshlrev_b32 v222, 16, v125
  v_and_b32 v223, 0xffff0000, v125
  v_lshlrev_b32 v224, 16, v126
  v_and_b32 v225, 0xffff0000, v126
  v_lshlrev_b32 v226, 16, v127
  v_and_b32 v227, 0xffff0000, v127
  v_fmac_f32 v31, v6, v237
  v_pk_fma_f32 v[32:33], v[220:221], v[6:7], v[32:33] op_sel_hi:[1,0,1]
  v_pk_fma_f32 v[34:35], v[222:223], v[6:7], v[34:35] op_sel_hi:[1,0,1]
  v_pk_fma_f32 v[36:37], v[224:225], v[6:7], v[36:37] op_sel_hi:[1,0,1]
  v_pk_fma_f32 v[38:39], v[226:227], v[6:7], v[38:39] op_sel_hi:[1,0,1]
  s_cmp_le_u32 s90, 2
  s_cbranch_scc1 L_ac_2
  v_sub_f32 v6, v238, v5
  v_exp_f32 v6, v6
  v_lshlrev_b32 v220, 16, v128
  v_and_b32 v221, 0xffff0000, v128
  v_lshlrev_b32 v222, 16, v129
  v_and_b32 v223, 0xffff0000, v129
  v_lshlrev_b32 v224, 16, v130
  v_and_b32 v225, 0xffff0000, v130
  v_lshlrev_b32 v226, 16, v131
  v_and_b32 v227, 0xffff0000, v131
  v_fmac_f32 v31, v6, v239
  v_pk_fma_f32 v[32:33], v[220:221], v[6:7], v[32:33] op_sel_hi:[1,0,1]
  v_pk_fma_f32 v[34:35], v[222:223], v[6:7], v[34:35] op_sel_hi:[1,0,1]
  v_pk_fma_f32 v[36:37], v[224:225], v[6:7], v[36:37] op_sel_hi:[1,0,1]
  v_pk_fma_f32 v[38:39], v[226:227], v[6:7], v[38:39] op_sel_hi:[1,0,1]
  s_cmp_le_u32 s90, 3
  s_cbranch_scc1 L_ac_2
  v_sub_f32 v6, v240, v5
  v_exp_f32 v6, v6
  v_lshlrev_b32 v220, 16, v132
  v_and_b32 v221, 0xffff0000, v132
  v_lshlrev_b32 v222, 16, v133
  v_and_b32 v223, 0xffff0000, v133
  v_lshlrev_b32 v224, 16, v134
  v_and_b32 v225, 0xffff0000, v134
  v_lshlrev_b32 v226, 16, v135
  v_and_b32 v227, 0xffff0000, v135
  v_fmac_f32 v31, v6, v241
  v_pk_fma_f32 v[32:33], v[220:221], v[6:7], v[32:33] op_sel_hi:[1,0,1]
  v_pk_fma_f32 v[34:35], v[222:223], v[6:7], v[34:35] op_sel_hi:[1,0,1]
  v_pk_fma_f32 v[36:37], v[224:225], v[6:7], v[36:37] op_sel_hi:[1,0,1]
  v_pk_fma_f32 v[38:39], v[226:227], v[6:7], v[38:39] op_sel_hi:[1,0,1]
  s_cmp_le_u32 s90, 4
  s_cbranch_scc1 L_ac_2
  v_sub_f32 v6, v242, v5
  v_exp_f32 v6, v6
  v_lshlrev_b32 v220, 16, v136
  v_and_b32 v221, 0xffff0000, v136
  v_lshlrev_b32 v222, 16, v137
  v_and_b32 v223, 0xffff0000, v137
  v_lshlrev_b32 v224, 16, v138
  v_and_b32 v225, 0xffff0000, v138
  v_lshlrev_b32 v226, 16, v139
  v_and_b32 v227, 0xffff0000, v139
  v_fmac_f32 v31, v6, v243
  v_pk_fma_f32 v[32:33], v[220:221], v[6:7], v[32:33] op_sel_hi:[1,0,1]
  v_pk_fma_f32 v[34:35], v[222:223], v[6:7], v[34:35] op_sel_hi:[1,0,1]
  v_pk_fma_f32 v[36:37], v[224:225], v[6:7], v[36:37] op_sel_hi:[1,0,1]
  v_pk_fma_f32 v[38:39], v[226:227], v[6:7], v[38:39] op_sel_hi:[1,0,1]
  s_cmp_le_u32 s90, 5
  s_cbranch_scc1 L_ac_2
  v_sub_f32 v6, v244, v5
  v_exp_f32 v6, v6
  v_lshlrev_b32 v220, 16, v140
  v_and_b32 v221, 0xffff0000, v140
  v_lshlrev_b32 v222, 16, v141
  v_and_b32 v223, 0xffff0000, v141
  v_lshlrev_b32 v224, 16, v142
  v_and_b32 v225, 0xffff0000, v142
  v_lshlrev_b32 v226, 16, v143
  v_and_b32 v227, 0xffff0000, v143
  v_fmac_f32 v31, v6, v245
  v_pk_fma_f32 v[32:33], v[220:221], v[6:7], v[32:33] op_sel_hi:[1,0,1]
  v_pk_fma_f32 v[34:35], v[222:223], v[6:7], v[34:35] op_sel_hi:[1,0,1]
  v_pk_fma_f32 v[36:37], v[224:225], v[6:7], v[36:37] op_sel_hi:[1,0,1]
  v_pk_fma_f32 v[38:39], v[226:227], v[6:7], v[38:39] op_sel_hi:[1,0,1]
  s_cmp_le_u32 s90, 6
  s_cbranch_scc1 L_ac_2
  v_sub_f32 v6, v246, v5
  v_exp_f32 v6, v6
  v_lshlrev_b32 v220, 16, v144
  v_and_b32 v221, 0xffff0000, v144
  v_lshlrev_b32 v222, 16, v145
  v_and_b32 v223, 0xffff0000, v145
  v_lshlrev_b32 v224, 16, v146
  v_and_b32 v225, 0xffff0000, v146
  v_lshlrev_b32 v226, 16, v147
  v_and_b32 v227, 0xffff0000, v147
  v_fmac_f32 v31, v6, v247
  v_pk_fma_f32 v[32:33], v[220:221], v[6:7], v[32:33] op_sel_hi:[1,0,1]
  v_pk_fma_f32 v[34:35], v[222:223], v[6:7], v[34:35] op_sel_hi:[1,0,1]
  v_pk_fma_f32 v[36:37], v[224:225], v[6:7], v[36:37] op_sel_hi:[1,0,1]
  v_pk_fma_f32 v[38:39], v[226:227], v[6:7], v[38:39] op_sel_hi:[1,0,1]
  s_cmp_le_u32 s90, 7
  s_cbranch_scc1 L_ac_2
  v_sub_f32 v6, v248, v5
  v_exp_f32 v6, v6
  v_lshlrev_b32 v220, 16, v148
  v_and_b32 v221, 0xffff0000, v148
  v_lshlrev_b32 v222, 16, v149
  v_and_b32 v223, 0xffff0000, v149
  v_lshlrev_b32 v224, 16, v150
  v_and_b32 v225, 0xffff0000, v150
  v_lshlrev_b32 v226, 16, v151
  v_and_b32 v227, 0xffff0000, v151
  v_fmac_f32 v31, v6, v249
  v_pk_fma_f32 v[32:33], v[220:221], v[6:7], v[32:33] op_sel_hi:[1,0,1]
  v_pk_fma_f32 v[34:35], v[222:223], v[6:7], v[34:35] op_sel_hi:[1,0,1]
  v_pk_fma_f32 v[36:37], v[224:225], v[6:7], v[36:37] op_sel_hi:[1,0,1]
  v_pk_fma_f32 v[38:39], v[226:227], v[6:7], v[38:39] op_sel_hi:[1,0,1]
  s_cmp_le_u32 s90, 8
  s_cbranch_scc1 L_ac_2
  v_sub_f32 v6, v250, v5
  v_exp_f32 v6, v6
  v_lshlrev_b32 v220, 16, v152
  v_and_b32 v221, 0xffff0000, v152
  v_lshlrev_b32 v222, 16, v153
  v_and_b32 v223, 0xffff0000, v153
  v_lshlrev_b32 v224, 16, v154
  v_and_b32 v225, 0xffff0000, v154
  v_lshlrev_b32 v226, 16, v155
  v_and_b32 v227, 0xffff0000, v155
  v_fmac_f32 v31, v6, v251
  v_pk_fma_f32 v[32:33], v[220:221], v[6:7], v[32:33] op_sel_hi:[1,0,1]
  v_pk_fma_f32 v[34:35], v[222:223], v[6:7], v[34:35] op_sel_hi:[1,0,1]
  v_pk_fma_f32 v[36:37], v[224:225], v[6:7], v[36:37] op_sel_hi:[1,0,1]
  v_pk_fma_f32 v[38:39], v[226:227], v[6:7], v[38:39] op_sel_hi:[1,0,1]
  s_cmp_le_u32 s90, 9
  s_cbranch_scc1 L_ac_2
  v_sub_f32 v6, v252, v5
  v_exp_f32 v6, v6
  v_lshlrev_b32 v220, 16, v156
  v_and_b32 v221, 0xffff0000, v156
  v_lshlrev_b32 v222, 16, v157
  v_and_b32 v223, 0xffff0000, v157
  v_lshlrev_b32 v224, 16, v158
  v_and_b32 v225, 0xffff0000, v158
  v_lshlrev_b32 v226, 16, v159
  v_and_b32 v227, 0xffff0000, v159
  v_fmac_f32 v31, v6, v253
  v_pk_fma_f32 v[32:33], v[220:221], v[6:7], v[32:33] op_sel_hi:[1,0,1]
  v_pk_fma_f32 v[34:35], v[222:223], v[6:7], v[34:35] op_sel_hi:[1,0,1]
  v_pk_fma_f32 v[36:37], v[224:225], v[6:7], v[36:37] op_sel_hi:[1,0,1]
  v_pk_fma_f32 v[38:39], v[226:227], v[6:7], v[38:39] op_sel_hi:[1,0,1]
L_ac_2:
L_mathed:
  s_add_u32 s36, s36, 10
  s_cmp_lt_u32 s36, s81
  s_cbranch_scc1 L_cpass
  s_lshl_b32 s82, s66, 18
  s_lshl_b32 s83, s64, 16
  s_add_u32 s82, s82, s83
  v_rcp_f32 v6, v11
  s_lshr_b32 s83, s35, 2
  s_lshl_b32 s83, s83, 12
  v_mov_b32 v7, v6
  v_pk_mul_f32 v[12:13], v[12:13], v[6:7]
  v_pk_mul_f32 v[14:15], v[14:15], v[6:7]
  v_pk_mul_f32 v[16:17], v[16:17], v[6:7]
  v_pk_mul_f32 v[18:19], v[18:19], v[6:7]
  v_cvt_pk_bf16_f32 v220, v12, v13
  v_cvt_pk_bf16_f32 v221, v14, v15
  v_cvt_pk_bf16_f32 v222, v16, v17
  v_cvt_pk_bf16_f32 v223, v18, v19
  s_and_b32 s84, s35, 3
  s_lshl_b32 s84, s84, 6
  s_add_u32 s83, s83, s84
  s_add_u32 s83, s83, s82
  v_permlane16_swap_b32 v220, v222
  v_permlane16_swap_b32 v221, v223
  s_nop 1
  buffer_store_dwordx4 v[220:223], v4, s[56:59], s83 offen sc1
  s_add_u32 s35, s35, s33
  s_cmp_ge_u32 s35, 64
  s_cbranch_scc1 L_share_done
  v_rcp_f32 v6, v21
  s_lshr_b32 s83, s35, 2
  s_lshl_b32 s83, s83, 12
  v_mov_b32 v7, v6
  v_pk_mul_f32 v[22:23], v[22:23], v[6:7]
  v_pk_mul_f32 v[24:25], v[24:25], v[6:7]
  v_pk_mul_f32 v[26:27], v[26:27], v[6:7]
  v_pk_mul_f32 v[28:29], v[28:29], v[6:7]
  v_cvt_pk_bf16_f32 v224, v22, v23
  v_cvt_pk_bf16_f32 v225, v24, v25
  v_cvt_pk_bf16_f32 v226, v26, v27
  v_cvt_pk_bf16_f32 v227, v28, v29
  s_and_b32 s84, s35, 3
  s_lshl_b32 s84, s84, 6
  s_add_u32 s83, s83, s84
  s_add_u32 s83, s83, s82
  v_permlane16_swap_b32 v224, v226
  v_permlane16_swap_b32 v225, v227
  s_nop 1
  buffer_store_dwordx4 v[224:227], v4, s[56:59], s83 offen sc1
  s_add_u32 s35, s35, s33
  s_cmp_ge_u32 s35, 64
  s_cbranch_scc1 L_share_done
  v_rcp_f32 v6, v31
  s_lshr_b32 s83, s35, 2
  s_lshl_b32 s83, s83, 12
  v_mov_b32 v7, v6
  v_pk_mul_f32 v[32:33], v[32:33], v[6:7]
  v_pk_mul_f32 v[34:35], v[34:35], v[6:7]
  v_pk_mul_f32 v[36:37], v[36:37], v[6:7]
  v_pk_mul_f32 v[38:39], v[38:39], v[6:7]
  v_cvt_pk_bf16_f32 v228, v32, v33
  v_cvt_pk_bf16_f32 v229, v34, v35
  v_cvt_pk_bf16_f32 v230, v36, v37
  v_cvt_pk_bf16_f32 v231, v38, v39
  s_and_b32 s84, s35, 3
  s_lshl_b32 s84, s84, 6
  s_add_u32 s83, s83, s84
  s_add_u32 s83, s83, s82
  v_permlane16_swap_b32 v228, v230
  v_permlane16_swap_b32 v229, v231
  s_nop 1
  buffer_store_dwordx4 v[228:231], v4, s[56:59], s83 offen sc1
  s_add_u32 s35, s35, s33
  s_branch L_upass
L_share_done:
  s_cmp_lg_u32 s37, 3
  s_cbranch_scc1 L_not_early
  s_waitcnt vmcnt(0)
  s_barrier
  buffer_load_dword v8, v206, s[48:51], s21 offen offset:128 sc1
  s_mov_b32 s37, 1
L_not_early:
  s_cmp_lg_u32 s37, 1
  s_cbranch_scc1 L_sweep_next
  s_waitcnt vmcnt(0)
  v_readfirstlane_b32 s41, v8
  s_mov_b32 s37, 0
  s_nop 0
L_sweep_next:
  s_cmp_eq_u32 s41, 0
  s_cbranch_scc1 L_fin
  s_ff1_i32_b32 s34, s41
  s_bitset0_b32 s41, s34
  s_branch L_share
L_fin:
  s_endpgm
L_exit1w:
  s_waitcnt vmcnt(0)
L_exit1:
  s_endpgm
L_redo:
  s_waitcnt vmcnt(0)
  s_barrier
  s_sub_u32 s84, s72, 1
  s_sub_u32 s85, s71, 1
  v_add_u32 v194, s85, v161
  v_mov_b32 v195, s84
  v_cmp_eq_u32 vcc, 0, v161
  s_lshl_b32 s86, s66, 11
  s_and_b32 s87, s20, 1
  v_cndmask_b32 v194, v194, v195, vcc
  s_lshl_b32 s87, s87, 2
  s_add_u32 s86, s86, s87
  v_lshlrev_b32 v194, 3, v194
  v_add_u32 v194, s86, v194
  s_sub_u32 s87, s72, s71
  s_lshl_b32 s86, s64, 8
  buffer_load_dword v144, v194, s[48:51], 0 offen
  s_lshl_b32 s88, s66, 18
  s_lshl_b32 s91, s64, 16
  s_add_u32 s88, s88, s91
  s_add_u32 s88, s88, s89
  s_mov_b32 s91, s90
  s_add_u32 s92, s88, s91
  s_add_u32 m0, s79, 65536
  s_nop 0
  buffer_load_dwordx4 v202, s[56:59], s92 offen offset:0 lds
  buffer_load_dwordx4 v203, s[56:59], s92 offen offset:1024 lds
  buffer_load_dwordx4 v204, s[56:59], s92 offen offset:2048 lds
  buffer_load_dwordx4 v205, s[56:59], s92 offen offset:3072 lds
  s_add_u32 m0, s79, 81920
  s_add_u32 s92, s92, 4096
  buffer_load_dwordx4 v202, s[56:59], s92 offen offset:0 lds
  buffer_load_dwordx4 v203, s[56:59], s92 offen offset:1024 lds
  buffer_load_dwordx4 v204, s[56:59], s92 offen offset:2048 lds
  buffer_load_dwordx4 v205, s[56:59], s92 offen offset:3072 lds
  v_mov_b32 v195, 0x80000000
  v_cmp_gt_u32 vcc, s87, v161
  s_waitcnt vmcnt(8)
  v_lshlrev_b32 v144, 14, v144
  v_add_u32 v144, s86, v144
  v_cndmask_b32 v144, v195, v144, vcc
  s_nop 0
  v_readlane_b32 s93, v144, 0
  v_readlane_b32 s94, v144, 1
  s_nop 2
  s_add_u32 m0, s79, 0
  s_nop 0
  buffer_load_dwordx4 v140, s[52:55], s93 offen offset:0 nt lds
  buffer_load_dwordx4 v141, s[52:55], s93 offen offset:1024 nt lds
  buffer_load_dwordx4 v142, s[52:55], s93 offen offset:2048 nt lds
  buffer_load_dwordx4 v143, s[52:55], s93 offen offset:3072 nt lds
  s_xor_b32 s91, s90, 0x2000
  s_add_u32 s92, s88, s91
  s_add_u32 m0, s79, 98304
  s_nop 0
  buffer_load_dwordx4 v202, s[56:59], s92 offen offset:0 lds
  buffer_load_dwordx4 v203, s[56:59], s92 offen offset:1024 lds
  buffer_load_dwordx4 v204, s[56:59], s92 offen offset:2048 lds
  buffer_load_dwordx4 v205, s[56:59], s92 offen offset:3072 lds
  s_add_u32 m0, s79, 114688
  s_add_u32 s92, s92, 4096
  buffer_load_dwordx4 v202, s[56:59], s92 offen offset:0 lds
  buffer_load_dwordx4 v203, s[56:59], s92 offen offset:1024 lds
  buffer_load_dwordx4 v204, s[56:59], s92 offen offset:2048 lds
  buffer_load_dwordx4 v205, s[56:59], s92 offen offset:3072 lds
  s_add_u32 m0, s79, 16384
  s_nop 0
  buffer_load_dwordx4 v140, s[52:55], s94 offen offset:0 nt lds
  buffer_load_dwordx4 v141, s[52:55], s94 offen offset:1024 nt lds
  buffer_load_dwordx4 v142, s[52:55], s94 offen offset:2048 nt lds
  buffer_load_dwordx4 v143, s[52:55], s94 offen offset:3072 nt lds
  s_branch L_redo_back
L_stub_b1:
  s_call_b64 s[22:23], L_rare_b
  s_branch L_back_b1
L_stub_a1:
  s_call_b64 s[22:23], L_rare_a
  s_branch L_back_a1
L_stub_b2:
  s_call_b64 s[22:23], L_rare_b
  s_branch L_back_b2
L_stub_a2:
  s_call_b64 s[22:23], L_rare_a
  s_branch L_back_a2
L_stub_b3:
  s_call_b64 s[22:23], L_rare_b
  s_branch L_back_b3
L_stub_a3:
  s_call_b64 s[22:23], L_rare_a
  s_branch L_back_a3
L_stub_b0:
  s_call_b64 s[22:23], L_rare_b
  s_branch L_back_b0
L_stub_a0:
  s_call_b64 s[22:23], L_rare_a
  s_branch L_back_a0
L_stub_bd:
  s_call_b64 s[22:23], L_rare_b
  s_branch L_back_bd
L_rare_a:
  s_nop 7
  v_max3_f32 v182, v64, v65, v66
  v_max3_f32 v182, v182, v67, v68
  v_max3_f32 v182, v182, v69, v70
  v_max_f32 v182, v182, v71
  v_mov_b32 v195, v182
  s_nop 1
  v_permlane32_swap_b32 v182, v195
  s_nop 1
  v_max_f32 v182, v182, v195
  v_mov_b32 v195, v182
  s_nop 1
  v_permlane16_swap_b32 v182, v195
  s_nop 1
  v_max_f32 v182, v182, v195
  v_add_f32 v182, 0x40e00000, v182
  v_max_f32 v182, 0, v182
  v_exp_f32 v183, -v182
  v_add_f32 v178, v178, v182
  v_sub_f32 v64, v64, v182
  v_sub_f32 v65, v65, v182
  v_sub_f32 v66, v66, v182
  v_sub_f32 v67, v67, v182
  v_sub_f32 v68, v68, v182
  v_sub_f32 v69, v69, v182
  v_sub_f32 v70, v70, v182
  v_sub_f32 v71, v71, v182
  v_sub_f32 v96, 0, v178
  v_sub_f32 v97, 0, v178
  v_sub_f32 v98, 0, v178
  v_sub_f32 v99, 0, v178
  v_mul_f32 v224, v224, v183
  v_mul_f32 v225, v225, v183
  v_mul_f32 v226, v226, v183
  v_mul_f32 v227, v227, v183
  v_accvgpr_read_b32 v196, a0
  v_accvgpr_read_b32 v197, a1
  v_accvgpr_read_b32 v198, a2
  v_accvgpr_read_b32 v199, a3
  v_mul_f32 v196, v196, v183
  v_mul_f32 v197, v197, v183
  v_mul_f32 v198, v198, v183
  v_mul_f32 v199, v199, v183
  v_accvgpr_write_b32 a0, v196
  v_accvgpr_write_b32 a1, v197
  v_accvgpr_write_b32 a2, v198
  v_accvgpr_write_b32 a3, v199
  v_accvgpr_read_b32 v196, a4
  v_accvgpr_read_b32 v197, a5
  v_accvgpr_read_b32 v198, a6
  v_accvgpr_read_b32 v199, a7
  v_mul_f32 v196, v196, v183
  v_mul_f32 v197, v197, v183
  v_mul_f32 v198, v198, v183
  v_mul_f32 v199, v199, v183
  v_accvgpr_write_b32 a4, v196
  v_accvgpr_write_b32 a5, v197
  v_accvgpr_write_b32 a6, v198
  v_accvgpr_write_b32 a7, v199
  v_accvgpr_read_b32 v196, a8
  v_accvgpr_read_b32 v197, a9
  v_accvgpr_read_b32 v198, a10
  v_accvgpr_read_b32 v199, a11
  v_mul_f32 v196, v196, v183
  v_mul_f32 v197, v197, v183
  v_mul_f32 v198, v198, v183
  v_mul_f32 v199, v199, v183
  v_accvgpr_write_b32 a8, v196
  v_accvgpr_write_b32 a9, v197
  v_accvgpr_write_b32 a10, v198
  v_accvgpr_write_b32 a11, v199
  v_accvgpr_read_b32 v196, a12
  v_accvgpr_read_b32 v197, a13
  v_accvgpr_read_b32 v198, a14
  v_accvgpr_read_b32 v199, a15
  v_mul_f32 v196, v196, v183
  v_mul_f32 v197, v197, v183
  v_mul_f32 v198, v198, v183
  v_mul_f32 v199, v199, v183
  v_accvgpr_write_b32 a12, v196
  v_accvgpr_write_b32 a13, v197
  v_accvgpr_write_b32 a14, v198
  v_accvgpr_write_b32 a15, v199
  v_accvgpr_read_b32 v196, a16
  v_accvgpr_read_b32 v197, a17
  v_accvgpr_read_b32 v198, a18
  v_accvgpr_read_b32 v199, a19
  v_mul_f32 v196, v196, v183
  v_mul_f32 v197, v197, v183
  v_mul_f32 v198, v198, v183
  v_mul_f32 v199, v199, v183
  v_accvgpr_write_b32 a16, v196
  v_accvgpr_write_b32 a17, v197
  v_accvgpr_write_b32 a18, v198
  v_accvgpr_write_b32 a19, v199
  v_accvgpr_read_b32 v196, a20
  v_accvgpr_read_b32 v197, a21
  v_accvgpr_read_b32 v198, a22
  v_accvgpr_read_b32 v199, a23
  v_mul_f32 v196, v196, v183
  v_mul_f32 v197, v197, v183
  v_mul_f32 v198, v198, v183
  v_mul_f32 v199, v199, v183
  v_accvgpr_write_b32 a20, v196
  v_accvgpr_write_b32 a21, v197
  v_accvgpr_write_b32 a22, v198
  v_accvgpr_write_b32 a23, v199
  v_accvgpr_read_b32 v196, a24
  v_accvgpr_read_b32 v197, a25
  v_accvgpr_read_b32 v198, a26
  v_accvgpr_read_b32 v199, a27
  v_mul_f32 v196, v196, v183
  v_mul_f32 v197, v197, v183
  v_mul_f32 v198, v198, v183
  v_mul_f32 v199, v199, v183
  v_accvgpr_write_b32 a24, v196
  v_accvgpr_write_b32 a25, v197
  v_accvgpr_write_b32 a26, v198
  v_accvgpr_write_b32 a27, v199
  v_accvgpr_read_b32 v196, a28
  v_accvgpr_read_b32 v197, a29
  v_accvgpr_read_b32 v198, a30
  v_accvgpr_read_b32 v199, a31
  v_mul_f32 v196, v196, v183
  v_mul_f32 v197, v197, v183
  v_mul_f32 v198, v198, v183
  v_mul_f32 v199, v199, v183
  v_accvgpr_write_b32 a28, v196
  v_accvgpr_write_b32 a29, v197
  v_accvgpr_write_b32 a30, v198
  v_accvgpr_write_b32 a31, v199
  v_max3_f32 v184, v72, v73, v74
  v_max3_f32 v184, v184, v75, v76
  v_max3_f32 v184, v184, v77, v78
  v_max_f32 v184, v184, v79
  v_mov_b32 v195, v184
  s_nop 1
  v_permlane32_swap_b32 v184, v195
  s_nop 1
  v_max_f32 v184, v184, v195
  v_mov_b32 v195, v184
  s_nop 1
  v_permlane16_swap_b32 v184, v195
  s_nop 1
  v_max_f32 v184, v184, v195
  v_add_f32 v184, 0x40e00000, v184
  v_max_f32 v184, 0, v184
  v_exp_f32 v185, -v184
  v_add_f32 v179, v179, v184
  v_sub_f32 v72, v72, v184
  v_sub_f32 v73, v73, v184
  v_sub_f32 v74, v74, v184
  v_sub_f32 v75, v75, v184
  v_sub_f32 v76, v76, v184
  v_sub_f32 v77, v77, v184
  v_sub_f32 v78, v78, v184
  v_sub_f32 v79, v79, v184
  v_sub_f32 v100, 0, v179
  v_sub_f32 v101, 0, v179
  v_sub_f32 v102, 0, v179
  v_sub_f32 v103, 0, v179
  v_mul_f32 v228, v228, v185
  v_mul_f32 v229, v229, v185
  v_mul_f32 v230, v230, v185
  v_mul_f32 v231, v231, v185
  v_accvgpr_read_b32 v196, a32
  v_accvgpr_read_b32 v197, a33
  v_accvgpr_read_b32 v198, a34
  v_accvgpr_read_b32 v199, a35
  v_mul_f32 v196, v196, v185
  v_mul_f32 v197, v197, v185
  v_mul_f32 v198, v198, v185
  v_mul_f32 v199, v199, v185
  v_accvgpr_write_b32 a32, v196
  v_accvgpr_write_b32 a33, v197
  v_accvgpr_write_b32 a34, v198
  v_accvgpr_write_b32 a35, v199
  v_accvgpr_read_b32 v196, a36
  v_accvgpr_read_b32 v197, a37
  v_accvgpr_read_b32 v198, a38
  v_accvgpr_read_b32 v199, a39
  v_mul_f32 v196, v196, v185
  v_mul_f32 v197, v197, v185
  v_mul_f32 v198, v198, v185
  v_mul_f32 v199, v199, v185
  v_accvgpr_write_b32 a36, v196
  v_accvgpr_write_b32 a37, v197
  v_accvgpr_write_b32 a38, v198
  v_accvgpr_write_b32 a39, v199
  v_accvgpr_read_b32 v196, a40
  v_accvgpr_read_b32 v197, a41
  v_accvgpr_read_b32 v198, a42
  v_accvgpr_read_b32 v199, a43
  v_mul_f32 v196, v196, v185
  v_mul_f32 v197, v197, v185
  v_mul_f32 v198, v198, v185
  v_mul_f32 v199, v199, v185
  v_accvgpr_write_b32 a40, v196
  v_accvgpr_write_b32 a41, v197
  v_accvgpr_write_b32 a42, v198
  v_accvgpr_write_b32 a43, v199
  v_accvgpr_read_b32 v196, a44
  v_accvgpr_read_b32 v197, a45
  v_accvgpr_read_b32 v198, a46
  v_accvgpr_read_b32 v199, a47
  v_mul_f32 v196, v196, v185
  v_mul_f32 v197, v197, v185
  v_mul_f32 v198, v198, v185
  v_mul_f32 v199, v199, v185
  v_accvgpr_write_b32 a44, v196
  v_accvgpr_write_b32 a45, v197
  v_accvgpr_write_b32 a46, v198
  v_accvgpr_write_b32 a47, v199
  v_accvgpr_read_b32 v196, a48
  v_accvgpr_read_b32 v197, a49
  v_accvgpr_read_b32 v198, a50
  v_accvgpr_read_b32 v199, a51
  v_mul_f32 v196, v196, v185
  v_mul_f32 v197, v197, v185
  v_mul_f32 v198, v198, v185
  v_mul_f32 v199, v199, v185
  v_accvgpr_write_b32 a48, v196
  v_accvgpr_write_b32 a49, v197
  v_accvgpr_write_b32 a50, v198
  v_accvgpr_write_b32 a51, v199
  v_accvgpr_read_b32 v196, a52
  v_accvgpr_read_b32 v197, a53
  v_accvgpr_read_b32 v198, a54
  v_accvgpr_read_b32 v199, a55
  v_mul_f32 v196, v196, v185
  v_mul_f32 v197, v197, v185
  v_mul_f32 v198, v198, v185
  v_mul_f32 v199, v199, v185
  v_accvgpr_write_b32 a52, v196
  v_accvgpr_write_b32 a53, v197
  v_accvgpr_write_b32 a54, v198
  v_accvgpr_write_b32 a55, v199
  v_accvgpr_read_b32 v196, a56
  v_accvgpr_read_b32 v197, a57
  v_accvgpr_read_b32 v198, a58
  v_accvgpr_read_b32 v199, a59
  v_mul_f32 v196, v196, v185
  v_mul_f32 v197, v197, v185
  v_mul_f32 v198, v198, v185
  v_mul_f32 v199, v199, v185
  v_accvgpr_write_b32 a56, v196
  v_accvgpr_write_b32 a57, v197
  v_accvgpr_write_b32 a58, v198
  v_accvgpr_write_b32 a59, v199
  v_accvgpr_read_b32 v196, a60
  v_accvgpr_read_b32 v197, a61
  v_accvgpr_read_b32 v198, a62
  v_accvgpr_read_b32 v199, a63
  v_mul_f32 v196, v196, v185
  v_mul_f32 v197, v197, v185
  v_mul_f32 v198, v198, v185
  v_mul_f32 v199, v199, v185
  v_accvgpr_write_b32 a60, v196
  v_accvgpr_write_b32 a61, v197
  v_accvgpr_write_b32 a62, v198
  v_accvgpr_write_b32 a63, v199
  v_exp_f32 v162, v64
  v_exp_f32 v163, v65
  v_exp_f32 v164, v66
  v_cvt_pk_bf16_f32 v112, v162, v163
  v_exp_f32 v165, v67
  v_exp_f32 v166, v68
  v_cvt_pk_bf16_f32 v113, v164, v165
  v_exp_f32 v167, v69
  v_exp_f32 v168, v70
  v_cvt_pk_bf16_f32 v114, v166, v167
  v_exp_f32 v169, v71
  v_exp_f32 v162, v72
  v_cvt_pk_bf16_f32 v115, v168, v169
  v_exp_f32 v163, v73
  v_or3_b32 v170, v112, v113, v114
  v_exp_f32 v164, v74
  v_cvt_pk_bf16_f32 v116, v162, v163
  v_exp_f32 v165, v75
  v_exp_f32 v166, v76
  v_cvt_pk_bf16_f32 v117, v164, v165
  v_exp_f32 v167, v77
  v_or3_b32 v170, v170, v115, v116
  v_exp_f32 v168, v78
  v_cvt_pk_bf16_f32 v118, v166, v167
  v_exp_f32 v169, v79
  s_nop 0
  v_cvt_pk_bf16_f32 v119, v168, v169
  v_or3_b32 v170, v170, v117, v118
  v_bitop3_b32 v170, v170, v119, s80 bitop3:0xa8
  v_cmp_ne_u32 vcc, 0, v170
  s_nop 1
  s_setpc_b64 s[22:23]
L_rare_b:
  s_nop 7
  v_max3_f32 v182, v80, v81, v82
  v_max3_f32 v182, v182, v83, v84
  v_max3_f32 v182, v182, v85, v86
  v_max_f32 v182, v182, v87
  v_mov_b32 v195, v182
  s_nop 1
  v_permlane32_swap_b32 v182, v195
  s_nop 1
  v_max_f32 v182, v182, v195
  v_mov_b32 v195, v182
  s_nop 1
  v_permlane16_swap_b32 v182, v195
  s_nop 1
  v_max_f32 v182, v182, v195
  v_add_f32 v182, 0x40e00000, v182
  v_max_f32 v182, 0, v182
  v_exp_f32 v183, -v182
  v_add_f32 v180, v180, v182
  v_sub_f32 v80, v80, v182
  v_sub_f32 v81, v81, v182
  v_sub_f32 v82, v82, v182
  v_sub_f32 v83, v83, v182
  v_sub_f32 v84, v84, v182
  v_sub_f32 v85, v85, v182
  v_sub_f32 v86, v86, v182
  v_sub_f32 v87, v87, v182
  v_sub_f32 v104, 0, v180
  v_sub_f32 v105, 0, v180
  v_sub_f32 v106, 0, v180
  v_sub_f32 v107, 0, v180
  v_mul_f32 v232, v232, v183
  v_mul_f32 v233, v233, v183
  v_mul_f32 v234, v234, v183
  v_mul_f32 v235, v235, v183
  v_accvgpr_read_b32 v196, a64
  v_accvgpr_read_b32 v197, a65
  v_accvgpr_read_b32 v198, a66
  v_accvgpr_read_b32 v199, a67
  v_mul_f32 v196, v196, v183
  v_mul_f32 v197, v197, v183
  v_mul_f32 v198, v198, v183
  v_mul_f32 v199, v199, v183
  v_accvgpr_write_b32 a64, v196
  v_accvgpr_write_b32 a65, v197
  v_accvgpr_write_b32 a66, v198
  v_accvgpr_write_b32 a67, v199
  v_accvgpr_read_b32 v196, a68
  v_accvgpr_read_b32 v197, a69
  v_accvgpr_read_b32 v198, a70
  v_accvgpr_read_b32 v199, a71
  v_mul_f32 v196, v196, v183
  v_mul_f32 v197, v197, v183
  v_mul_f32 v198, v198, v183
  v_mul_f32 v199, v199, v183
  v_accvgpr_write_b32 a68, v196
  v_accvgpr_write_b32 a69, v197
  v_accvgpr_write_b32 a70, v198
  v_accvgpr_write_b32 a71, v199
  v_accvgpr_read_b32 v196, a72
  v_accvgpr_read_b32 v197, a73
  v_accvgpr_read_b32 v198, a74
  v_accvgpr_read_b32 v199, a75
  v_mul_f32 v196, v196, v183
  v_mul_f32 v197, v197, v183
  v_mul_f32 v198, v198, v183
  v_mul_f32 v199, v199, v183
  v_accvgpr_write_b32 a72, v196
  v_accvgpr_write_b32 a73, v197
  v_accvgpr_write_b32 a74, v198
  v_accvgpr_write_b32 a75, v199
  v_accvgpr_read_b32 v196, a76
  v_accvgpr_read_b32 v197, a77
  v_accvgpr_read_b32 v198, a78
  v_accvgpr_read_b32 v199, a79
  v_mul_f32 v196, v196, v183
  v_mul_f32 v197, v197, v183
  v_mul_f32 v198, v198, v183
  v_mul_f32 v199, v199, v183
  v_accvgpr_write_b32 a76, v196
  v_accvgpr_write_b32 a77, v197
  v_accvgpr_write_b32 a78, v198
  v_accvgpr_write_b32 a79, v199
  v_accvgpr_read_b32 v196, a80
  v_accvgpr_read_b32 v197, a81
  v_accvgpr_read_b32 v198, a82
  v_accvgpr_read_b32 v199, a83
  v_mul_f32 v196, v196, v183
  v_mul_f32 v197, v197, v183
  v_mul_f32 v198, v198, v183
  v_mul_f32 v199, v199, v183
  v_accvgpr_write_b32 a80, v196
  v_accvgpr_write_b32 a81, v197
  v_accvgpr_write_b32 a82, v198
  v_accvgpr_write_b32 a83, v199
  v_accvgpr_read_b32 v196, a84
  v_accvgpr_read_b32 v197, a85
  v_accvgpr_read_b32 v198, a86
  v_accvgpr_read_b32 v199, a87
  v_mul_f32 v196, v196, v183
  v_mul_f32 v197, v197, v183
  v_mul_f32 v198, v198, v183
  v_mul_f32 v199, v199, v183
  v_accvgpr_write_b32 a84, v196
  v_accvgpr_write_b32 a85, v197
  v_accvgpr_write_b32 a86, v198
  v_accvgpr_write_b32 a87, v199
  v_accvgpr_read_b32 v196, a88
  v_accvgpr_read_b32 v197, a89
  v_accvgpr_read_b32 v198, a90
  v_accvgpr_read_b32 v199, a91
  v_mul_f32 v196, v196, v183
  v_mul_f32 v197, v197, v183
  v_mul_f32 v198, v198, v183
  v_mul_f32 v199, v199, v183
  v_accvgpr_write_b32 a88, v196
  v_accvgpr_write_b32 a89, v197
  v_accvgpr_write_b32 a90, v198
  v_accvgpr_write_b32 a91, v199
  v_accvgpr_read_b32 v196, a92
  v_accvgpr_read_b32 v197, a93
  v_accvgpr_read_b32 v198, a94
  v_accvgpr_read_b32 v199, a95
  v_mul_f32 v196, v196, v183
  v_mul_f32 v197, v197, v183
  v_mul_f32 v198, v198, v183
  v_mul_f32 v199, v199, v183
  v_accvgpr_write_b32 a92, v196
  v_accvgpr_write_b32 a93, v197
  v_accvgpr_write_b32 a94, v198
  v_accvgpr_write_b32 a95, v199
  v_max3_f32 v184, v88, v89, v90
  v_max3_f32 v184, v184, v91, v92
  v_max3_f32 v184, v184, v93, v94
  v_max_f32 v184, v184, v95
  v_mov_b32 v195, v184
  s_nop 1
  v_permlane32_swap_b32 v184, v195
  s_nop 1
  v_max_f32 v184, v184, v195
  v_mov_b32 v195, v184
  s_nop 1
  v_permlane16_swap_b32 v184, v195
  s_nop 1
  v_max_f32 v184, v184, v195
  v_add_f32 v184, 0x40e00000, v184
  v_max_f32 v184, 0, v184
  v_exp_f32 v185, -v184
  v_add_f32 v181, v181, v184
  v_sub_f32 v88, v88, v184
  v_sub_f32 v89, v89, v184
  v_sub_f32 v90, v90, v184
  v_sub_f32 v91, v91, v184
  v_sub_f32 v92, v92, v184
  v_sub_f32 v93, v93, v184
  v_sub_f32 v94, v94, v184
  v_sub_f32 v95, v95, v184
  v_sub_f32 v108, 0, v181
  v_sub_f32 v109, 0, v181
  v_sub_f32 v110, 0, v181
  v_sub_f32 v111, 0, v181
  v_mul_f32 v236, v236, v185
  v_mul_f32 v237, v237, v185
  v_mul_f32 v238, v238, v185
  v_mul_f32 v239, v239, v185
  v_accvgpr_read_b32 v196, a96
  v_accvgpr_read_b32 v197, a97
  v_accvgpr_read_b32 v198, a98
  v_accvgpr_read_b32 v199, a99
  v_mul_f32 v196, v196, v185
  v_mul_f32 v197, v197, v185
  v_mul_f32 v198, v198, v185
  v_mul_f32 v199, v199, v185
  v_accvgpr_write_b32 a96, v196
  v_accvgpr_write_b32 a97, v197
  v_accvgpr_write_b32 a98, v198
  v_accvgpr_write_b32 a99, v199
  v_accvgpr_read_b32 v196, a100
  v_accvgpr_read_b32 v197, a101
  v_accvgpr_read_b32 v198, a102
  v_accvgpr_read_b32 v199, a103
  v_mul_f32 v196, v196, v185
  v_mul_f32 v197, v197, v185
  v_mul_f32 v198, v198, v185
  v_mul_f32 v199, v199, v185
  v_accvgpr_write_b32 a100, v196
  v_accvgpr_write_b32 a101, v197
  v_accvgpr_write_b32 a102, v198
  v_accvgpr_write_b32 a103, v199
  v_accvgpr_read_b32 v196, a104
  v_accvgpr_read_b32 v197, a105
  v_accvgpr_read_b32 v198, a106
  v_accvgpr_read_b32 v199, a107
  v_mul_f32 v196, v196, v185
  v_mul_f32 v197, v197, v185
  v_mul_f32 v198, v198, v185
  v_mul_f32 v199, v199, v185
  v_accvgpr_write_b32 a104, v196
  v_accvgpr_write_b32 a105, v197
  v_accvgpr_write_b32 a106, v198
  v_accvgpr_write_b32 a107, v199
  v_accvgpr_read_b32 v196, a108
  v_accvgpr_read_b32 v197, a109
  v_accvgpr_read_b32 v198, a110
  v_accvgpr_read_b32 v199, a111
  v_mul_f32 v196, v196, v185
  v_mul_f32 v197, v197, v185
  v_mul_f32 v198, v198, v185
  v_mul_f32 v199, v199, v185
  v_accvgpr_write_b32 a108, v196
  v_accvgpr_write_b32 a109, v197
  v_accvgpr_write_b32 a110, v198
  v_accvgpr_write_b32 a111, v199
  v_accvgpr_read_b32 v196, a112
  v_accvgpr_read_b32 v197, a113
  v_accvgpr_read_b32 v198, a114
  v_accvgpr_read_b32 v199, a115
  v_mul_f32 v196, v196, v185
  v_mul_f32 v197, v197, v185
  v_mul_f32 v198, v198, v185
  v_mul_f32 v199, v199, v185
  v_accvgpr_write_b32 a112, v196
  v_accvgpr_write_b32 a113, v197
  v_accvgpr_write_b32 a114, v198
  v_accvgpr_write_b32 a115, v199
  v_accvgpr_read_b32 v196, a116
  v_accvgpr_read_b32 v197, a117
  v_accvgpr_read_b32 v198, a118
  v_accvgpr_read_b32 v199, a119
  v_mul_f32 v196, v196, v185
  v_mul_f32 v197, v197, v185
  v_mul_f32 v198, v198, v185
  v_mul_f32 v199, v199, v185
  v_accvgpr_write_b32 a116, v196
  v_accvgpr_write_b32 a117, v197
  v_accvgpr_write_b32 a118, v198
  v_accvgpr_write_b32 a119, v199
  v_accvgpr_read_b32 v196, a120
  v_accvgpr_read_b32 v197, a121
  v_accvgpr_read_b32 v198, a122
  v_accvgpr_read_b32 v199, a123
  v_mul_f32 v196, v196, v185
  v_mul_f32 v197, v197, v185
  v_mul_f32 v198, v198, v185
  v_mul_f32 v199, v199, v185
  v_accvgpr_write_b32 a120, v196
  v_accvgpr_write_b32 a121, v197
  v_accvgpr_write_b32 a122, v198
  v_accvgpr_write_b32 a123, v199
  v_accvgpr_read_b32 v196, a124
  v_accvgpr_read_b32 v197, a125
  v_accvgpr_read_b32 v198, a126
  v_accvgpr_read_b32 v199, a127
  v_mul_f32 v196, v196, v185
  v_mul_f32 v197, v197, v185
  v_mul_f32 v198, v198, v185
  v_mul_f32 v199, v199, v185
  v_accvgpr_write_b32 a124, v196
  v_accvgpr_write_b32 a125, v197
  v_accvgpr_write_b32 a126, v198
  v_accvgpr_write_b32 a127, v199
  v_exp_f32 v152, v80
  v_exp_f32 v153, v81
  v_exp_f32 v154, v82
  v_cvt_pk_bf16_f32 v120, v152, v153
  v_exp_f32 v155, v83
  v_exp_f32 v156, v84
  v_cvt_pk_bf16_f32 v121, v154, v155
  v_exp_f32 v157, v85
  v_exp_f32 v158, v86
  v_cvt_pk_bf16_f32 v122, v156, v157
  v_exp_f32 v159, v87
  v_exp_f32 v152, v88
  v_cvt_pk_bf16_f32 v123, v158, v159
  v_exp_f32 v153, v89
  v_or3_b32 v172, v120, v121, v122
  v_exp_f32 v154, v90
  v_cvt_pk_bf16_f32 v124, v152, v153
  v_exp_f32 v155, v91
  v_exp_f32 v156, v92
  v_cvt_pk_bf16_f32 v125, v154, v155
  v_exp_f32 v157, v93
  v_or3_b32 v172, v172, v123, v124
  v_exp_f32 v158, v94
  v_cvt_pk_bf16_f32 v126, v156, v157
  v_exp_f32 v159, v95
  s_nop 0
  v_cvt_pk_bf16_f32 v127, v158, v159
  v_or3_b32 v172, v172, v125, v126
  v_bitop3_b32 v172, v172, v127, s80 bitop3:0xa8
  v_cmp_ne_u32 vcc, 0, v172
  s_nop 1
  s_setpc_b64 s[22:23]
.section .rodata,"a"
.p2align 6
.amdhsa_kernel standalone__paged_block_table_kv_pagedattention__sampling_kernel
  .amdhsa_next_free_vgpr 456
  .amdhsa_next_free_sgpr 102
  .amdhsa_accum_offset 256
  .amdhsa_group_segment_fixed_size 0
  .amdhsa_kernarg_size 64
  .amdhsa_user_sgpr_count 2
  .amdhsa_user_sgpr_kernarg_segment_ptr 1
  .amdhsa_system_sgpr_workgroup_id_x 1
.end_amdhsa_kernel
```
